```python
import torch

def _softmax(x, axis=-1):
    return torch.softmax(x, dim=axis)
def _gelu(x):
    return torch.nn.functional.gelu(x, approximate="tanh")
def _silu(x):
    return torch.nn.functional.silu(x)
def _sigmoid(x):
    return torch.sigmoid(x)
def _layernorm(x, axis=-1, eps=1e-5):
    m = x.mean(dim=axis, keepdim=True)
    v = x.var(dim=axis, keepdim=True, unbiased=False)
    return (x - m) / torch.sqrt(v + eps)
def _scatter_add(tgt, idx, src, axis=0):
    return tgt.clone().index_add_(axis, idx, src)
def _segment_sum(src, seg, n):
    out = torch.zeros((n,) + src.shape[1:], dtype=src.dtype)
    return out.index_add_(0, seg, src)
def _pad(x, pw):
    flat = tuple(v for pair in reversed(pw) for v in pair)
    return torch.nn.functional.pad(x, flat)

kernel_name = 'standalone__mha_block_cached__near_ridge'

def setup_inputs():

    _w = (lambda a: (lambda t: t.to(torch.bfloat16) if t.is_floating_point() else t)(torch.as_tensor(a)))
    B, Sq, D = 8, 192, 512
    H, Sk, Dh = 32, 512, 128
    return {
        "x": _w((lambda *s: torch.randn(*s, dtype=torch.bfloat16) * 0.8)(B, Sq, D)),
        "k_cache": _w((lambda *s: torch.randn(*s, dtype=torch.bfloat16) * 0.8)(B, H, Sk, Dh)),
        "v_cache": _w((lambda *s: torch.randn(*s, dtype=torch.bfloat16) * 0.05)(B, H, Sk, Dh)),
        "wq": _w((lambda *s: torch.randn(*s, dtype=torch.bfloat16) * 0.8)(D, H * Dh) * (D ** -0.5)),
        "wo": _w((lambda *s: torch.randn(*s, dtype=torch.bfloat16) * 0.05)(H * Dh, D) * ((H * Dh) ** -0.5)),
    }

def reference(x, k_cache, v_cache, wq, wo):
    B, Sq, D = x.shape
    H, Dh = 32, 128
    q = (lambda x, *d: x.permute(*d))((x @ wq).reshape(B, Sq, H, Dh), 0, 2, 1, 3)
    scores = torch.einsum("bhqd,bhkd->bhqk", q, k_cache) * (Dh ** -0.5)
    p = _softmax(scores, axis=-1)
    o = torch.einsum("bhqk,bhkd->bhqd", p, v_cache)
    return (lambda x, *d: x.permute(*d))(o, 0, 2, 1, 3).reshape(B, Sq, H * Dh) @ wo
```

```asm
; @launch grid=(256,1,1) block=(256,1,1) lds=163840
.amdgcn_target "amdgcn-amd-amdhsa--gfx950"
.text
.globl standalone__mha_block_cached__near_ridge_kernel
.p2align 8
.type standalone__mha_block_cached__near_ridge_kernel,@function
standalone__mha_block_cached__near_ridge_kernel:
    s_cmp_ge_u32 s2, 256
    s_cbranch_scc1 L_end
    s_load_dwordx16 s[4:19], s[0:1], 0
    s_getpc_b64 s[90:91]
L_pc:
    s_lshr_b32 s83, s2, 3
    s_lshl_b32 s92, s83, 11
    v_lshl_add_u32 v2, v0, 6, s92
    v_min_u32 v2, L_codeend-L_pc-4, v2
    v_mov_b32 v3, s91
    v_add_co_u32 v2, vcc, s90, v2
    v_lshrrev_b32 v1, 6, v0
    s_and_b32 s82, s2, 7
    v_addc_co_u32 v3, vcc, 0, v3, vcc
    v_cmp_gt_u32 vcc, 32, v0
    v_and_b32 v0, 63, v0
    v_readfirstlane_b32 s22, v1
    s_and_saveexec_b64 s[26:27], vcc
    s_cbranch_execz L_nopf
    global_load_dword v255, v[2:3], off
L_nopf:
    s_mov_b64 exec, -1
    s_and_b32 s20, s82, 4
    s_and_b32 s84, s83, 3
    s_add_u32 s20, s20, s84
    s_and_b32 s21, s82, 3
    s_lshl_b32 s21, s21, 3
    s_lshr_b32 s83, s83, 2
    s_add_u32 s21, s21, s83
    s_lshl_b32 s23, s84, 1
    s_add_u32 s23, s23, s21
    v_lshrrev_b32 v2, 4, v0
    v_and_b32 v3, 15, v0
    v_lshrrev_b32 v4, 3, v0
    v_and_b32 v5, 7, v0
    v_lshl_add_u32 v6, v1, 4, v2
    v_lshlrev_b32 v6, 13, v6
    v_lshlrev_b32 v7, 1, v2
    v_xor_b32 v7, v7, v3
    v_lshl_add_u32 v204, v7, 4, v6
    v_add_u32 v205, 31744, v204
    v_xor_b32 v206, 128, v204
    v_add_u32 v206, 63488, v206
    v_add_u32 v207, 31744, v206
    v_mul_u32_u24 v6, 48, v1
    v_add_u32 v6, v6, v4
    v_lshlrev_b32 v6, 10, v6
    v_xor_b32 v7, v5, v2
    v_lshl_add_u32 v200, v7, 4, v6
    v_xor_b32 v201, 64, v200
    v_add_u32 v201, 7168, v201
    s_lshl_b32 s72, s22, 11
    s_lshl_b32 s73, s22, 12
    s_add_u32 s82, s23, 1
    s_and_b32 s82, s82, 7
    s_lshl_b32 s56, s82, 7
    s_lshl_b32 s64, s82, 19
    s_add_u32 s82, s23, 2
    s_and_b32 s82, s82, 7
    s_lshl_b32 s57, s82, 7
    s_lshl_b32 s65, s82, 19
    s_add_u32 s82, s23, 3
    s_and_b32 s82, s82, 7
    s_lshl_b32 s58, s82, 7
    s_lshl_b32 s66, s82, 19
    s_lshl_b32 s82, s21, 8
    s_mul_i32 s83, s20, 196608
    s_lshl_b32 s84, s20, 12
    s_add_u32 s84, s84, 41943040
    s_mov_b32 s27, 0x20000
    s_mov_b32 s31, 0x20000
    s_mov_b32 s26, 196608
    s_sub_u32 s30, 0x400000, s82
    s_waitcnt lgkmcnt(0)
    s_add_u32 s28, s10, s82
    s_addc_u32 s29, s11, 0
    s_and_b32 s29, s29, 0xffff
    s_add_u32 s24, s4, s83
    s_addc_u32 s25, s5, 0
    s_and_b32 s25, s25, 0xffff
    s_load_dword s80, s[18:19], s84
    s_add_u32 m0, s73, 57344
    s_nop 0
    buffer_load_dwordx4 v204, s[28:31], s64 offen lds
    buffer_load_dwordx4 v205, s[28:31], s64 offen offset:1024 lds
    buffer_load_dwordx4 v206, s[28:31], s64 offen offset:2048 lds
    buffer_load_dwordx4 v207, s[28:31], s64 offen offset:3072 lds
    s_add_u32 m0, s72, 98304
    s_add_u32 s79, s56, 0
    buffer_load_dwordx4 v200, s[24:27], s79 offen lds
    buffer_load_dwordx4 v201, s[24:27], s79 offen offset:1024 lds
    s_add_u32 m0, s72, 106496
    s_add_u32 s79, s56, 16384
    buffer_load_dwordx4 v200, s[24:27], s79 offen lds
    buffer_load_dwordx4 v201, s[24:27], s79 offen offset:1024 lds
    s_add_u32 m0, s72, 114688
    s_add_u32 s79, s56, 32768
    buffer_load_dwordx4 v200, s[24:27], s79 offen lds
    buffer_load_dwordx4 v201, s[24:27], s79 offen offset:1024 lds
    v_bfe_u32 v6, v0, 2, 2
    v_and_b32 v7, 3, v0
    v_lshlrev_b32 v7, 3, v7
    v_and_b32 v249, 1, v2
    v_lshl_add_u32 v249, v249, 2, v6
    v_lshl_add_u32 v220, v249, 5, v7
    v_lshl_add_u32 v250, v2, 3, v6
    v_lshl_add_u32 v188, v250, 8, v220
    v_add_u32 v188, 40960, v188
    v_xor_b32 v189, 32, v188
    v_xor_b32 v190, 64, v188
    v_xor_b32 v191, 96, v188
    v_xor_b32 v192, 128, v188
    v_xor_b32 v193, 160, v188
    v_xor_b32 v194, 192, v188
    v_xor_b32 v195, 224, v188
    v_lshrrev_b32 v249, 1, v3
    v_xor_b32 v249, v249, v2
    v_lshlrev_b32 v249, 4, v249
    v_lshl_add_u32 v249, v3, 7, v249
    v_lshl_add_u32 v196, v1, 11, v249
    v_add_u32 v196, 90112, v196
    v_xor_b32 v197, 64, v196
    s_add_u32 m0, s72, 122880
    s_add_u32 s79, s57, 0
    buffer_load_dwordx4 v200, s[24:27], s79 offen lds
    buffer_load_dwordx4 v201, s[24:27], s79 offen offset:1024 lds
    s_add_u32 m0, s72, 131072
    s_add_u32 s79, s57, 16384
    buffer_load_dwordx4 v200, s[24:27], s79 offen lds
    buffer_load_dwordx4 v201, s[24:27], s79 offen offset:1024 lds
    s_add_u32 m0, s72, 90112
    s_add_u32 s79, s57, 32768
    buffer_load_dwordx4 v200, s[24:27], s79 offen lds
    buffer_load_dwordx4 v201, s[24:27], s79 offen offset:1024 lds
    s_add_u32 m0, s73, 73728
    s_nop 0
    buffer_load_dwordx4 v204, s[28:31], s65 offen lds
    buffer_load_dwordx4 v205, s[28:31], s65 offen offset:1024 lds
    buffer_load_dwordx4 v206, s[28:31], s65 offen offset:2048 lds
    buffer_load_dwordx4 v207, s[28:31], s65 offen offset:3072 lds
    s_lshl_b32 s84, s20, 5
    s_add_u32 s84, s84, s21
    s_lshl_b32 s82, s84, 17
    s_add_u32 s32, s6, s82
    s_addc_u32 s33, s7, 0
    s_and_b32 s33, s33, 0xffff
    s_add_u32 s36, s8, s82
    s_addc_u32 s37, s9, 0
    s_and_b32 s37, s37, 0xffff
    s_mov_b32 s34, 0x20000
    s_mov_b32 s35, 0x20000
    s_mov_b32 s38, 0x20000
    s_mov_b32 s39, 0x20000
    v_lshl_add_u32 v249, v1, 3, v2
    v_and_b32 v250, 15, v249
    v_xor_b32 v250, v250, v3
    v_lshlrev_b32 v250, 4, v250
    v_lshl_add_u32 v228, v249, 8, v250
    v_xor_b32 v229, 64, v228
    v_lshlrev_b32 v250, 1, v2
    v_xor_b32 v250, v250, v3
    v_lshlrev_b32 v250, 4, v250
    v_lshl_add_u32 v230, v249, 8, v250
    v_xor_b32 v231, 128, v230
    s_add_u32 m0, s72, 0
    s_mov_b32 s76, 0
    buffer_load_dwordx4 v228, s[32:35], s76 offen nt lds
    buffer_load_dwordx4 v229, s[32:35], s76 offen offset:1024 nt lds
    s_add_u32 m0, s72, 8192
    s_mov_b32 s76, 8192
    buffer_load_dwordx4 v228, s[32:35], s76 offen nt lds
    buffer_load_dwordx4 v229, s[32:35], s76 offen offset:1024 nt lds
    s_add_u32 m0, s72, 155648
    s_mov_b32 s77, 0
    buffer_load_dwordx4 v230, s[36:39], s77 offen nt lds
    buffer_load_dwordx4 v231, s[36:39], s77 offen offset:1024 nt lds
    s_mov_b64 exec, 0
    s_cmp_eq_u32 s22, 0
    s_cbranch_scc1 L_pg0
    s_cmp_eq_u32 s22, 1
    s_cbranch_scc1 L_pg1
    s_cmp_eq_u32 s22, 2
    s_cbranch_scc1 L_pg2
    s_branch L_pg3
L_warmed:
    s_mov_b64 exec, -1
    s_branch L_main
.p2align 12
L_main:
L_pg0:
    s_cbranch_execz L_pg4
    s_waitcnt vmcnt(22)
    s_barrier
    s_waitcnt vmcnt(20)
    ds_read_b128 a[64:67], v196 offset:8192
    ds_read_b128 a[68:71], v197 offset:8192
    s_waitcnt vmcnt(18)
    ds_read_b128 a[72:75], v196 offset:16384
    ds_read_b128 a[76:79], v197 offset:16384
    s_waitcnt vmcnt(16)
    ds_read_b128 a[80:83], v196 offset:24576
    ds_read_b128 a[84:87], v197 offset:24576
    ds_read_b64_tr_b16 a[0:1], v188 offset:16384
    ds_read_b64_tr_b16 a[2:3], v188 offset:17408
    ds_read_b64_tr_b16 a[4:5], v188 offset:24576
    ds_read_b64_tr_b16 a[6:7], v188 offset:25600
    ds_read_b64_tr_b16 a[8:9], v189 offset:16384
    ds_read_b64_tr_b16 a[10:11], v189 offset:17408
    s_add_u32 m0, s73, 40960
    s_waitcnt lgkmcnt(4)
    v_mfma_f32_16x16x32_bf16 v[8:11], a[0:3], a[64:67], 0
    s_waitcnt lgkmcnt(2)
    s_add_u32 s82, s23, 4
    ds_read_b64_tr_b16 a[12:13], v189 offset:24576
    ds_read_b64_tr_b16 a[14:15], v189 offset:25600
    v_mfma_f32_16x16x32_bf16 v[8:11], a[4:7], a[68:71], v[8:11]
    s_and_b32 s82, s82, 7
    buffer_load_dwordx4 v204, s[28:31], s66 offen lds
    v_lshlrev_b32 v248, 4, v0
    v_mfma_f32_16x16x32_bf16 v[40:43], a[0:3], a[72:75], 0
    s_lshl_b32 s59, s82, 7
    ds_read_b64_tr_b16 a[16:17], v190 offset:16384
    v_lshl_add_u32 v249, v1, 3, v2
    v_mfma_f32_16x16x32_bf16 v[40:43], a[4:7], a[76:79], v[40:43]
    s_lshl_b32 s67, s82, 19
    ds_read_b64_tr_b16 a[18:19], v190 offset:17408
    v_and_b32 v250, 15, v249
    v_mfma_f32_16x16x32_bf16 v[72:75], a[0:3], a[80:83], 0
    s_add_u32 s82, s23, 5
    ds_read_b64_tr_b16 a[20:21], v190 offset:24576
    ds_read_b64_tr_b16 a[22:23], v190 offset:25600
    v_mfma_f32_16x16x32_bf16 v[72:75], a[4:7], a[84:87], v[72:75]
    s_waitcnt lgkmcnt(6)
    s_and_b32 s82, s82, 7
    buffer_load_dwordx4 v205, s[28:31], s66 offen offset:1024 lds
    v_xor_b32 v250, v250, v3
    v_mfma_f32_16x16x32_bf16 v[12:15], a[8:11], a[64:67], 0
    s_waitcnt lgkmcnt(4)
    s_lshl_b32 s60, s82, 7
    ds_read_b64_tr_b16 a[24:25], v191 offset:16384
    v_lshlrev_b32 v250, 4, v250
    v_mfma_f32_16x16x32_bf16 v[12:15], a[12:15], a[68:71], v[12:15]
    s_lshl_b32 s68, s82, 19
    ds_read_b64_tr_b16 a[26:27], v191 offset:17408
    v_lshl_add_u32 v228, v249, 8, v250
    v_mfma_f32_16x16x32_bf16 v[44:47], a[8:11], a[72:75], 0
    s_add_u32 s82, s23, 6
    ds_read_b64_tr_b16 a[28:29], v191 offset:24576
    v_xor_b32 v229, 64, v228
    v_mfma_f32_16x16x32_bf16 v[44:47], a[12:15], a[76:79], v[44:47]
    s_and_b32 s82, s82, 7
    buffer_load_dwordx4 v206, s[28:31], s66 offen offset:2048 lds
    v_lshlrev_b32 v250, 1, v2
    v_mfma_f32_16x16x32_bf16 v[76:79], a[8:11], a[80:83], 0
    s_lshl_b32 s61, s82, 7
    ds_read_b64_tr_b16 a[30:31], v191 offset:25600
    v_xor_b32 v250, v250, v3
    v_mfma_f32_16x16x32_bf16 v[76:79], a[12:15], a[84:87], v[76:79]
    s_waitcnt lgkmcnt(6)
    s_lshl_b32 s69, s82, 19
    ds_read_b64_tr_b16 a[32:33], v192 offset:16384
    v_lshlrev_b32 v250, 4, v250
    v_mfma_f32_16x16x32_bf16 v[16:19], a[16:19], a[64:67], 0
    s_waitcnt lgkmcnt(5)
    s_add_u32 s79, s58, 0
    ds_read_b64_tr_b16 a[34:35], v192 offset:17408
    v_lshl_add_u32 v230, v249, 8, v250
    v_mfma_f32_16x16x32_bf16 v[16:19], a[20:23], a[68:71], v[16:19]
    s_add_u32 s82, s23, 7
    buffer_load_dwordx4 v207, s[28:31], s66 offen offset:3072 lds
    v_xor_b32 v231, 128, v230
    v_mfma_f32_16x16x32_bf16 v[48:51], a[16:19], a[72:75], 0
    s_add_u32 m0, s72, 98304
    ds_read_b64_tr_b16 a[36:37], v192 offset:24576
    v_lshl_add_u32 v244, v249, 10, v250
    v_mfma_f32_16x16x32_bf16 v[48:51], a[20:23], a[76:79], v[48:51]
    s_and_b32 s82, s82, 7
    ds_read_b64_tr_b16 a[38:39], v192 offset:25600
    v_xor_b32 v245, 128, v244
    v_mfma_f32_16x16x32_bf16 v[80:83], a[16:19], a[80:83], 0
    s_lshl_b32 s62, s82, 7
    ds_read_b64_tr_b16 a[40:41], v193 offset:16384
    v_add_u32 v245, 3072, v245
    v_mfma_f32_16x16x32_bf16 v[80:83], a[20:23], a[84:87], v[80:83]
    s_waitcnt lgkmcnt(6)
    s_lshl_b32 s70, s82, 19
    buffer_load_dwordx4 v200, s[24:27], s79 offen lds
    v_lshl_add_u32 v250, v2, 2, v6
    v_mfma_f32_16x16x32_bf16 v[20:23], a[24:27], a[64:67], 0
    s_waitcnt lgkmcnt(5)
    s_add_u32 s82, s23, 8
    ds_read_b64_tr_b16 a[42:43], v193 offset:17408
    v_lshl_add_u32 v220, v250, 8, v220
    v_mfma_f32_16x16x32_bf16 v[20:23], a[28:31], a[68:71], v[20:23]
    s_and_b32 s82, s82, 7
    ds_read_b64_tr_b16 a[44:45], v193 offset:24576
    v_add_u32 v220, 98304, v220
    v_mfma_f32_16x16x32_bf16 v[52:55], a[24:27], a[72:75], 0
    s_lshl_b32 s63, s82, 7
    ds_read_b64_tr_b16 a[46:47], v193 offset:25600
    v_xor_b32 v221, 32, v220
    v_mfma_f32_16x16x32_bf16 v[52:55], a[28:31], a[76:79], v[52:55]
    s_lshl_b32 s71, s82, 19
    buffer_load_dwordx4 v201, s[24:27], s79 offen offset:1024 lds
    v_xor_b32 v222, 64, v220
    v_mfma_f32_16x16x32_bf16 v[84:87], a[24:27], a[80:83], 0
    s_add_u32 s79, s58, 16384
    ds_read_b64_tr_b16 a[48:49], v194 offset:16384
    v_xor_b32 v223, 96, v220
    v_mfma_f32_16x16x32_bf16 v[84:87], a[28:31], a[84:87], v[84:87]
    s_waitcnt lgkmcnt(6)
    s_add_u32 m0, s72, 106496
    ds_read_b64_tr_b16 a[50:51], v194 offset:17408
    v_xor_b32 v224, 128, v220
    v_mfma_f32_16x16x32_bf16 v[24:27], a[32:35], a[64:67], 0
    s_waitcnt lgkmcnt(6)
    s_lshl_b32 s84, s20, 5
    ds_read_b64_tr_b16 a[52:53], v194 offset:24576
    v_xor_b32 v225, 160, v220
    v_mfma_f32_16x16x32_bf16 v[24:27], a[36:39], a[68:71], v[24:27]
    s_add_u32 s84, s84, s21
    buffer_load_dwordx4 v200, s[24:27], s79 offen lds
    v_xor_b32 v226, 192, v220
    v_mfma_f32_16x16x32_bf16 v[56:59], a[32:35], a[72:75], 0
    s_lshl_b32 s82, s84, 17
    ds_read_b64_tr_b16 a[54:55], v194 offset:25600
    v_xor_b32 v227, 224, v220
    v_mfma_f32_16x16x32_bf16 v[56:59], a[36:39], a[76:79], v[56:59]
    s_add_u32 s32, s6, s82
    s_addc_u32 s33, s7, 0
    ds_read_b64_tr_b16 a[56:57], v195 offset:16384
    v_and_b32 v249, 1, v2
    v_mfma_f32_16x16x32_bf16 v[88:91], a[32:35], a[80:83], 0
    s_and_b32 s33, s33, 0xffff
    ds_read_b64_tr_b16 a[58:59], v195 offset:17408
    v_lshrrev_b32 v250, 1, v2
    v_mfma_f32_16x16x32_bf16 v[88:91], a[36:39], a[84:87], v[88:91]
    s_waitcnt lgkmcnt(6)
    s_add_u32 s36, s8, s82
    s_addc_u32 s37, s9, 0
    buffer_load_dwordx4 v201, s[24:27], s79 offen offset:1024 lds
    v_lshl_add_u32 v249, v249, 1, v250
    v_mfma_f32_16x16x32_bf16 v[28:31], a[40:43], a[64:67], 0
    s_add_u32 s79, s58, 32768
    ds_read_b64_tr_b16 a[60:61], v195 offset:24576
    v_xor_b32 v249, v249, v3
    v_mfma_f32_16x16x32_bf16 v[28:31], a[44:47], a[68:71], v[28:31]
    s_add_u32 m0, s72, 114688
    ds_read_b64_tr_b16 a[62:63], v195 offset:25600
    v_lshlrev_b32 v249, 4, v249
    v_mfma_f32_16x16x32_bf16 v[60:63], a[40:43], a[72:75], 0
    s_waitcnt vmcnt(22)
    s_and_b32 s37, s37, 0xffff
    ds_read_b128 a[88:91], v196 offset:32768
    v_lshl_add_u32 v216, v3, 8, v249
    v_mfma_f32_16x16x32_bf16 v[60:63], a[44:47], a[76:79], v[60:63]
    s_mov_b32 s34, 0x20000
    buffer_load_dwordx4 v200, s[24:27], s79 offen lds
    v_xor_b32 v217, 64, v216
    v_mfma_f32_16x16x32_bf16 v[92:95], a[40:43], a[80:83], 0
    s_mov_b32 s35, 0x20000
    ds_read_b128 a[92:95], v197 offset:32768
    v_xor_b32 v218, 128, v216
    v_mfma_f32_16x16x32_bf16 v[92:95], a[44:47], a[84:87], v[92:95]
    s_waitcnt lgkmcnt(6)
    s_mov_b32 s38, 0x20000
    v_xor_b32 v219, 192, v216
    v_mov_b32 v212, 0x3f803f80
    v_mfma_f32_16x16x32_bf16 v[32:35], a[48:51], a[64:67], 0
    s_mov_b32 s39, 0x20000
    v_mov_b32 v213, 0x3f803f80
    v_mov_b32 v214, 0x3f803f80
    v_mfma_f32_16x16x32_bf16 v[32:35], a[52:55], a[68:71], v[32:35]
    s_mov_b32 s43, 0x20000
    buffer_load_dwordx4 v201, s[24:27], s79 offen offset:1024 lds
    v_mov_b32 v215, 0x3f803f80
    v_mfma_f32_16x16x32_bf16 v[64:67], a[48:51], a[72:75], 0
    s_add_u32 m0, s73, 57344
    v_mul_u32_u24 v251, 48, v1
    v_add_u32 v251, v251, v3
    v_lshlrev_b32 v251, 10, v251
    v_lshl_add_u32 v251, v2, 3, v251
    v_lshrrev_b32 v249, 11, s92
    v_lshl_add_u32 v249, v249, 2, v1
    v_and_b32 v250, 31, v0
    v_lshlrev_b32 v249, 5, v249
    v_add_u32 v249, v249, v250
    v_lshrrev_b32 v250, 9, v249
    v_and_b32 v249, 511, v249
    v_lshl_add_u32 v249, v250, 10, v249
    v_lshlrev_b32 v249, 7, v249
    v_and_b32 v250, 24, s21
    v_lshl_add_u32 v243, v250, 17, v249
    v_mfma_f32_16x16x32_bf16 v[64:67], a[52:55], a[76:79], v[64:67]
    s_mov_b32 s47, 0x20000
    global_load_dword v254, v243, s[12:13]
    v_mfma_f32_16x16x32_bf16 v[96:99], a[48:51], a[80:83], 0
    s_waitcnt vmcnt(17) lgkmcnt(2)
    s_barrier
    ds_read_b64_tr_b16 a[0:1], v188 offset:32768
    ds_read_b64_tr_b16 a[2:3], v188 offset:33792
    v_mfma_f32_16x16x32_bf16 v[96:99], a[52:55], a[84:87], v[96:99]
    s_mov_b32 s51, 0x20000
    buffer_load_dwordx4 v204, s[28:31], s67 offen lds
    ds_read_b64_tr_b16 a[4:5], v188 offset:40960
    v_mfma_f32_16x16x32_bf16 v[36:39], a[56:59], a[64:67], 0
    s_and_b32 s82, s2, 7
    ds_read_b128 a[96:99], v196 offset:40960
    ds_read_b64_tr_b16 a[6:7], v188 offset:41984
    v_mfma_f32_16x16x32_bf16 v[36:39], a[60:63], a[68:71], v[36:39]
    s_mul_i32 s82, s82, 0
    ds_read_b128 a[100:103], v197 offset:40960
    ds_read_b128 a[104:107], v196 offset:0
    v_mfma_f32_16x16x32_bf16 v[68:71], a[56:59], a[72:75], 0
    s_lshr_b32 s83, s2, 3
    ds_read_b128 a[108:111], v197 offset:0
    v_mfma_f32_16x16x32_bf16 v[68:71], a[60:63], a[76:79], v[68:71]
    s_mul_i32 s83, s83, 0
    buffer_load_dwordx4 v205, s[28:31], s67 offen offset:1024 lds
    ds_read_b64_tr_b16 a[8:9], v189 offset:32768
    v_mfma_f32_16x16x32_bf16 v[100:103], a[56:59], a[80:83], 0
    s_add_u32 s82, s82, s83
    ds_read_b64_tr_b16 a[10:11], v189 offset:33792
    ds_read_b64_tr_b16 a[12:13], v189 offset:40960
    v_mfma_f32_16x16x32_bf16 v[100:103], a[60:63], a[84:87], v[100:103]
    s_waitcnt lgkmcnt(9)
    s_and_b32 s82, s82, 15
    ds_read_b64_tr_b16 a[14:15], v189 offset:41984
    v_mfma_f32_16x16x32_bf16 v[8:11], a[0:3], a[88:91], v[8:11]
    s_waitcnt lgkmcnt(7)
    s_lshl_b32 s23, s82, 13
    ds_read_b64_tr_b16 a[16:17], v190 offset:32768
    v_mfma_f32_16x16x32_bf16 v[8:11], a[4:7], a[92:95], v[8:11]
    s_lshl_b32 s89, s84, 2
    buffer_load_dwordx4 v206, s[28:31], s67 offen offset:2048 lds
    v_mfma_f32_16x16x32_bf16 v[40:43], a[0:3], a[96:99], v[40:43]
    s_waitcnt lgkmcnt(7)
    s_add_u32 s79, s59, 0
    ds_read_b64_tr_b16 a[18:19], v190 offset:33792
    v_mfma_f32_16x16x32_bf16 v[40:43], a[4:7], a[100:103], v[40:43]
    s_waitcnt lgkmcnt(7)
    s_add_u32 s89, s89, s22
    ds_read_b64_tr_b16 a[20:21], v190 offset:40960
    v_mfma_f32_16x16x32_bf16 v[72:75], a[0:3], a[104:107], v[72:75]
    s_waitcnt lgkmcnt(7)
    s_mul_i32 s96, s89, 1152
    ds_read_b64_tr_b16 a[22:23], v190 offset:41984
    v_mfma_f32_16x16x32_bf16 v[72:75], a[4:7], a[108:111], v[72:75]
    s_waitcnt lgkmcnt(6)
    s_mul_i32 s89, s89, 10752
    buffer_load_dwordx4 v207, s[28:31], s67 offen offset:3072 lds
    v_mfma_f32_16x16x32_bf16 v[12:15], a[8:11], a[88:91], v[12:15]
    s_waitcnt lgkmcnt(4)
    s_add_u32 m0, s72, 122880
    ds_read_b64_tr_b16 a[24:25], v191 offset:32768
    v_mfma_f32_16x16x32_bf16 v[12:15], a[12:15], a[92:95], v[12:15]
    s_add_u32 s89, s89, 13631488
    ds_read_b64_tr_b16 a[26:27], v191 offset:33792
    v_mfma_f32_16x16x32_bf16 v[44:47], a[8:11], a[96:99], v[44:47]
    s_add_u32 s96, s96, 35651584
    ds_read_b64_tr_b16 a[28:29], v191 offset:40960
    v_mfma_f32_16x16x32_bf16 v[44:47], a[12:15], a[100:103], v[44:47]
    s_mul_i32 s82, s21, 4608
    buffer_load_dwordx4 v200, s[24:27], s79 offen lds
    v_mfma_f32_16x16x32_bf16 v[76:79], a[8:11], a[104:107], v[76:79]
    s_sub_u32 s88, s96, s82
    ds_read_b64_tr_b16 a[30:31], v191 offset:41984
    v_mfma_f32_16x16x32_bf16 v[76:79], a[12:15], a[108:111], v[76:79]
    s_waitcnt lgkmcnt(6)
    s_lshr_b32 s74, s21, 2
    ds_read_b64_tr_b16 a[32:33], v192 offset:32768
    v_mfma_f32_16x16x32_bf16 v[16:19], a[16:19], a[88:91], v[16:19]
    s_waitcnt lgkmcnt(5)
    s_and_b32 s75, s21, 3
    ds_read_b64_tr_b16 a[34:35], v192 offset:33792
    v_mfma_f32_16x16x32_bf16 v[16:19], a[20:23], a[92:95], v[16:19]
    s_lshr_b32 s87, s84, 2
    buffer_load_dwordx4 v201, s[24:27], s79 offen offset:1024 lds
    v_mfma_f32_16x16x32_bf16 v[48:51], a[16:19], a[96:99], v[48:51]
    s_add_u32 s79, s59, 16384
    ds_read_b64_tr_b16 a[36:37], v192 offset:40960
    v_mfma_f32_16x16x32_bf16 v[48:51], a[20:23], a[100:103], v[48:51]
    s_add_u32 m0, s72, 131072
    ds_read_b64_tr_b16 a[38:39], v192 offset:41984
    v_mfma_f32_16x16x32_bf16 v[80:83], a[16:19], a[104:107], v[80:83]
    s_lshl_b32 s87, s87, 2
    ds_read_b64_tr_b16 a[40:41], v193 offset:32768
    v_mfma_f32_16x16x32_bf16 v[80:83], a[20:23], a[108:111], v[80:83]
    s_waitcnt lgkmcnt(6)
    s_add_u32 s87, s87, s22
    buffer_load_dwordx4 v200, s[24:27], s79 offen lds
    v_mfma_f32_16x16x32_bf16 v[20:23], a[24:27], a[88:91], v[20:23]
    s_waitcnt lgkmcnt(5)
    s_mul_i32 s87, s87, 4224
    ds_read_b64_tr_b16 a[42:43], v193 offset:33792
    v_mfma_f32_16x16x32_bf16 v[20:23], a[28:31], a[92:95], v[20:23]
    s_add_u32 s87, s87, 33554432
    ds_read_b64_tr_b16 a[44:45], v193 offset:40960
    v_mfma_f32_16x16x32_bf16 v[52:55], a[24:27], a[96:99], v[52:55]
    s_lshl_b32 s82, s74, 19
    ds_read_b64_tr_b16 a[46:47], v193 offset:41984
    v_mfma_f32_16x16x32_bf16 v[52:55], a[28:31], a[100:103], v[52:55]
    s_lshl_b32 s83, s75, 8
    buffer_load_dwordx4 v201, s[24:27], s79 offen offset:1024 lds
    v_mfma_f32_16x16x32_bf16 v[84:87], a[24:27], a[104:107], v[84:87]
    s_waitcnt vmcnt(13)
    s_add_u32 s79, s59, 32768
    ds_read_b128 a[112:115], v196 offset:8192
    v_mfma_f32_16x16x32_bf16 v[84:87], a[28:31], a[108:111], v[84:87]
    s_waitcnt lgkmcnt(6)
    s_add_u32 m0, s72, 90112
    ds_read_b128 a[116:119], v197 offset:8192
    v_mfma_f32_16x16x32_bf16 v[24:27], a[32:35], a[88:91], v[24:27]
    s_waitcnt lgkmcnt(6)
    s_add_u32 s82, s82, s83
    ds_read_b64_tr_b16 a[48:49], v194 offset:32768
    v_mfma_f32_16x16x32_bf16 v[24:27], a[36:39], a[92:95], v[24:27]
    s_add_u32 s40, s12, s82
    s_addc_u32 s41, s13, 0
    buffer_load_dwordx4 v200, s[24:27], s79 offen lds
    v_mfma_f32_16x16x32_bf16 v[56:59], a[32:35], a[96:99], v[56:59]
    s_and_b32 s41, s41, 0xffff
    ds_read_b64_tr_b16 a[50:51], v194 offset:33792
    v_mfma_f32_16x16x32_bf16 v[56:59], a[36:39], a[100:103], v[56:59]
    s_sub_u32 s42, 0x400000, s82
    ds_read_b64_tr_b16 a[52:53], v194 offset:40960
    v_mfma_f32_16x16x32_bf16 v[88:91], a[32:35], a[104:107], v[88:91]
    s_mul_i32 s84, s20, 196608
    ds_read_b64_tr_b16 a[54:55], v194 offset:41984
    v_mfma_f32_16x16x32_bf16 v[88:91], a[36:39], a[108:111], v[88:91]
    s_waitcnt lgkmcnt(6)
    s_add_u32 s84, s84, s83
    buffer_load_dwordx4 v201, s[24:27], s79 offen offset:1024 lds
    v_mfma_f32_16x16x32_bf16 v[28:31], a[40:43], a[88:91], v[28:31]
    s_add_u32 s79, s60, 0
    ds_read_b64_tr_b16 a[56:57], v195 offset:32768
    v_mfma_f32_16x16x32_bf16 v[28:31], a[44:47], a[92:95], v[28:31]
    s_add_u32 m0, s72, 98304
    ds_read_b64_tr_b16 a[58:59], v195 offset:33792
    v_mfma_f32_16x16x32_bf16 v[60:63], a[40:43], a[96:99], v[60:63]
    s_lshl_b32 s82, s74, 5
    ds_read_b64_tr_b16 a[60:61], v195 offset:40960
    v_mfma_f32_16x16x32_bf16 v[60:63], a[44:47], a[100:103], v[60:63]
    s_waitcnt lgkmcnt(6)
    s_add_u32 s84, s84, s82
    ds_read_b64_tr_b16 a[62:63], v195 offset:41984
    buffer_load_dwordx4 v200, s[24:27], s79 offen lds
    v_mfma_f32_16x16x32_bf16 v[92:95], a[40:43], a[104:107], v[92:95]
    s_waitcnt vmcnt(14)
    s_add_u32 s48, s14, s84
    s_addc_u32 s49, s15, 0
    ds_read_b128 a[120:123], v196 offset:16384
    v_mfma_f32_16x16x32_bf16 v[92:95], a[44:47], a[108:111], v[92:95]
    s_waitcnt lgkmcnt(7)
    s_and_b32 s49, s49, 0xffff
    ds_read_b128 a[124:127], v197 offset:16384
    v_mfma_f32_16x16x32_bf16 v[32:35], a[48:51], a[88:91], v[32:35]
    s_waitcnt lgkmcnt(6)
    s_sub_u32 s50, 1572864, s84
    v_mfma_f32_16x16x32_bf16 v[32:35], a[52:55], a[92:95], v[32:35]
    s_mov_b32 s44, s18
    buffer_load_dwordx4 v201, s[24:27], s79 offen offset:1024 lds
    v_mfma_f32_16x16x32_bf16 v[64:67], a[48:51], a[96:99], v[64:67]
    s_waitcnt vmcnt(13)
    s_add_u32 m0, s73, 73728
    ds_read_b128 a[128:131], v196 offset:24576
    v_mfma_f32_16x16x32_bf16 v[64:67], a[52:55], a[100:103], v[64:67]
    s_and_b32 s45, s19, 0xffff
    ds_read_b128 a[132:135], v197 offset:24576
    v_mfma_f32_16x16x32_bf16 v[96:99], a[48:51], a[104:107], v[96:99]
    s_waitcnt lgkmcnt(4)
    s_barrier
    ds_read_b64_tr_b16 a[0:1], v188 offset:0
    ds_read_b64_tr_b16 a[2:3], v188 offset:1024
    v_mfma_f32_16x16x32_bf16 v[96:99], a[52:55], a[108:111], v[96:99]
    s_mov_b32 s46, 42008576
    buffer_load_dwordx4 v204, s[28:31], s68 offen lds
    ds_read_b64_tr_b16 a[4:5], v188 offset:8192
    v_mfma_f32_16x16x32_bf16 v[36:39], a[56:59], a[88:91], v[36:39]
    s_lshl_b32 s84, s20, 2
    ds_read_b64_tr_b16 a[6:7], v188 offset:9216
    v_mfma_f32_16x16x32_bf16 v[36:39], a[60:63], a[92:95], v[36:39]
    s_add_u32 s84, s84, s22
    ds_read_b64_tr_b16 a[8:9], v189 offset:0
    v_mfma_f32_16x16x32_bf16 v[68:71], a[56:59], a[96:99], v[68:71]
    s_lshl_b32 s84, s84, 5
    ds_read_b64_tr_b16 a[10:11], v189 offset:1024
    v_mfma_f32_16x16x32_bf16 v[68:71], a[60:63], a[100:103], v[68:71]
    s_xor_b32 s82, s21, 0
    buffer_load_dwordx4 v205, s[28:31], s68 offen offset:1024 lds
    v_mfma_f32_16x16x32_bf16 v[100:103], a[56:59], a[104:107], v[100:103]
    s_add_u32 s83, s84, s82
    ds_read_b64_tr_b16 a[12:13], v189 offset:8192
    ds_read_b64_tr_b16 a[14:15], v189 offset:9216
    v_mfma_f32_16x16x32_bf16 v[100:103], a[60:63], a[108:111], v[100:103]
    s_waitcnt lgkmcnt(6)
    s_mul_i32 s86, s83, 12288
    ds_read_b64_tr_b16 a[16:17], v190 offset:0
    v_mfma_f32_16x16x32_bf16 v[8:11], a[0:3], a[112:115], v[8:11]
    s_waitcnt lgkmcnt(5)
    s_and_b32 s82, s82, 3
    ds_read_b64_tr_b16 a[18:19], v190 offset:1024
    v_mfma_f32_16x16x32_bf16 v[8:11], a[4:7], a[116:119], v[8:11]
    s_lshl_b32 s52, s82, 17
    buffer_load_dwordx4 v206, s[28:31], s68 offen offset:2048 lds
    v_mfma_f32_16x16x32_bf16 v[40:43], a[0:3], a[120:123], v[40:43]
    s_add_u32 s79, s60, 16384
    ds_read_b64_tr_b16 a[20:21], v190 offset:8192
    v_mfma_f32_16x16x32_bf16 v[40:43], a[4:7], a[124:127], v[40:43]
    s_xor_b32 s82, s21, 1
    ds_read_b64_tr_b16 a[22:23], v190 offset:9216
    v_mfma_f32_16x16x32_bf16 v[72:75], a[0:3], a[128:131], v[72:75]
    s_add_u32 s83, s84, s82
    ds_read_b64_tr_b16 a[24:25], v191 offset:0
    v_mfma_f32_16x16x32_bf16 v[72:75], a[4:7], a[132:135], v[72:75]
    s_waitcnt lgkmcnt(7)
    s_mul_i32 s97, s83, 12288
    buffer_load_dwordx4 v207, s[28:31], s68 offen offset:3072 lds
    v_mfma_f32_16x16x32_bf16 v[12:15], a[8:11], a[112:115], v[12:15]
    s_waitcnt lgkmcnt(5)
    s_add_u32 m0, s72, 106496
    ds_read_b64_tr_b16 a[26:27], v191 offset:1024
    v_mfma_f32_16x16x32_bf16 v[12:15], a[12:15], a[116:119], v[12:15]
    s_and_b32 s82, s82, 3
    ds_read_b64_tr_b16 a[28:29], v191 offset:8192
    v_mfma_f32_16x16x32_bf16 v[44:47], a[8:11], a[120:123], v[44:47]
    s_lshl_b32 s53, s82, 17
    ds_read_b64_tr_b16 a[30:31], v191 offset:9216
    v_mfma_f32_16x16x32_bf16 v[44:47], a[12:15], a[124:127], v[44:47]
    s_xor_b32 s82, s21, 2
    buffer_load_dwordx4 v200, s[24:27], s79 offen lds
    v_mfma_f32_16x16x32_bf16 v[76:79], a[8:11], a[128:131], v[76:79]
    s_add_u32 s83, s84, s82
    ds_read_b64_tr_b16 a[32:33], v192 offset:0
    v_mfma_f32_16x16x32_bf16 v[76:79], a[12:15], a[132:135], v[76:79]
    s_waitcnt lgkmcnt(6)
    s_mul_i32 s98, s83, 12288
    ds_read_b64_tr_b16 a[34:35], v192 offset:1024
    v_mfma_f32_16x16x32_bf16 v[16:19], a[16:19], a[112:115], v[16:19]
    s_waitcnt lgkmcnt(6)
    s_and_b32 s82, s82, 3
    ds_read_b64_tr_b16 a[36:37], v192 offset:8192
    v_mfma_f32_16x16x32_bf16 v[16:19], a[20:23], a[116:119], v[16:19]
    s_lshl_b32 s54, s82, 17
    buffer_load_dwordx4 v201, s[24:27], s79 offen offset:1024 lds
    v_mfma_f32_16x16x32_bf16 v[48:51], a[16:19], a[120:123], v[48:51]
    s_add_u32 s79, s60, 32768
    ds_read_b64_tr_b16 a[38:39], v192 offset:9216
    v_mfma_f32_16x16x32_bf16 v[48:51], a[20:23], a[124:127], v[48:51]
    s_waitcnt vmcnt(12)
    s_add_u32 m0, s72, 114688
    ds_read_b128 a[136:139], v196 offset:32768
    v_mfma_f32_16x16x32_bf16 v[80:83], a[16:19], a[128:131], v[80:83]
    s_xor_b32 s82, s21, 3
    ds_read_b128 a[140:143], v197 offset:32768
    v_mfma_f32_16x16x32_bf16 v[80:83], a[20:23], a[132:135], v[80:83]
    s_waitcnt lgkmcnt(6)
    s_add_u32 s83, s84, s82
    buffer_load_dwordx4 v200, s[24:27], s79 offen lds
    v_mfma_f32_16x16x32_bf16 v[20:23], a[24:27], a[112:115], v[20:23]
    s_mul_i32 s99, s83, 12288
    ds_read_b64_tr_b16 a[40:41], v193 offset:0
    v_mfma_f32_16x16x32_bf16 v[20:23], a[28:31], a[116:119], v[20:23]
    s_and_b32 s82, s82, 3
    ds_read_b64_tr_b16 a[42:43], v193 offset:1024
    v_mfma_f32_16x16x32_bf16 v[52:55], a[24:27], a[120:123], v[52:55]
    s_lshl_b32 s55, s82, 17
    ds_read_b64_tr_b16 a[44:45], v193 offset:8192
    v_mfma_f32_16x16x32_bf16 v[52:55], a[28:31], a[124:127], v[52:55]
    s_mov_b32 s85, 0x4e800000
    buffer_load_dwordx4 v201, s[24:27], s79 offen offset:1024 lds
    v_mfma_f32_16x16x32_bf16 v[84:87], a[24:27], a[128:131], v[84:87]
    s_add_u32 s79, s61, 0
    ds_read_b64_tr_b16 a[46:47], v193 offset:9216
    v_mfma_f32_16x16x32_bf16 v[84:87], a[28:31], a[132:135], v[84:87]
    s_waitcnt vmcnt(12) lgkmcnt(6)
    s_add_u32 m0, s72, 122880
    ds_read_b128 a[144:147], v196 offset:40960
    v_mfma_f32_16x16x32_bf16 v[24:27], a[32:35], a[112:115], v[24:27]
    s_mov_b32 s81, 0x3e0293ee
    ds_read_b128 a[148:151], v197 offset:40960
    v_mfma_f32_16x16x32_bf16 v[24:27], a[36:39], a[116:119], v[24:27]
    s_waitcnt lgkmcnt(6)
    s_lshl_b32 s82, s75, 2
    buffer_load_dwordx4 v200, s[24:27], s79 offen lds
    v_mfma_f32_16x16x32_bf16 v[56:59], a[32:35], a[120:123], v[56:59]
    s_add_u32 s1, s82, s87
    ds_read_b64_tr_b16 a[48:49], v194 offset:0
    v_mfma_f32_16x16x32_bf16 v[56:59], a[36:39], a[124:127], v[56:59]
    s_lshl_b32 s83, s74, 4
    ds_read_b64_tr_b16 a[50:51], v194 offset:1024
    v_mfma_f32_16x16x32_bf16 v[88:91], a[32:35], a[128:131], v[88:91]
    s_getreg_b32 s0, hwreg(HW_REG_XCC_ID, 0, 4)
    ds_read_b64_tr_b16 a[52:53], v194 offset:8192
    ds_read_b64_tr_b16 a[54:55], v194 offset:9216
    v_mfma_f32_16x16x32_bf16 v[88:91], a[36:39], a[132:135], v[88:91]
    s_waitcnt lgkmcnt(7)
    s_add_u32 s0, s0, 1
    buffer_load_dwordx4 v201, s[24:27], s79 offen offset:1024 lds
    v_mfma_f32_16x16x32_bf16 v[28:31], a[40:43], a[112:115], v[28:31]
    s_waitcnt lgkmcnt(6)
    s_add_u32 s79, s61, 16384
    ds_read_b64_tr_b16 a[56:57], v195 offset:0
    v_mfma_f32_16x16x32_bf16 v[28:31], a[44:47], a[116:119], v[28:31]
    s_add_u32 m0, s72, 131072
    ds_read_b64_tr_b16 a[58:59], v195 offset:1024
    v_add_u32 v243, 65536, v243
    v_mfma_f32_16x16x32_bf16 v[60:63], a[40:43], a[120:123], v[60:63]
    s_lshl_b32 s0, s0, 24
    ds_read_b64_tr_b16 a[60:61], v195 offset:8192
    v_mfma_f32_16x16x32_bf16 v[60:63], a[44:47], a[124:127], v[60:63]
    s_waitcnt lgkmcnt(7)
    s_add_u32 s82, s96, 2097152
    ds_read_b64_tr_b16 a[62:63], v195 offset:9216
    buffer_load_dwordx4 v200, s[24:27], s79 offen lds
    v_mfma_f32_16x16x32_bf16 v[92:95], a[40:43], a[128:131], v[92:95]
    s_waitcnt vmcnt(13)
    ds_read_b128 a[152:155], v196 offset:0
    v_mfma_f32_16x16x32_bf16 v[92:95], a[44:47], a[132:135], v[92:95]
    s_waitcnt lgkmcnt(7)
    ds_read_b128 a[156:159], v197 offset:0
    v_mfma_f32_16x16x32_bf16 v[32:35], a[48:51], a[112:115], v[32:35]
    s_waitcnt lgkmcnt(6)
    v_mfma_f32_16x16x32_bf16 v[32:35], a[52:55], a[116:119], v[32:35]
    buffer_load_dwordx4 v201, s[24:27], s79 offen offset:1024 lds
    v_mfma_f32_16x16x32_bf16 v[64:67], a[48:51], a[120:123], v[64:67]
    s_waitcnt vmcnt(12)
    s_add_u32 m0, s73, 40960
    ds_read_b128 a[160:163], v196 offset:8192
    v_mfma_f32_16x16x32_bf16 v[64:67], a[52:55], a[124:127], v[64:67]
    global_load_dword v254, v243, s[12:13]
    v_mfma_f32_16x16x32_bf16 v[96:99], a[48:51], a[128:131], v[96:99]
    s_waitcnt lgkmcnt(3)
    s_barrier
    ds_read_b64_tr_b16 a[0:1], v188 offset:16384
    ds_read_b64_tr_b16 a[2:3], v188 offset:17408
    v_mfma_f32_16x16x32_bf16 v[96:99], a[52:55], a[132:135], v[96:99]
    buffer_load_dwordx4 v204, s[28:31], s69 offen lds
    ds_read_b64_tr_b16 a[4:5], v188 offset:24576
    v_mfma_f32_16x16x32_bf16 v[36:39], a[56:59], a[112:115], v[36:39]
    ds_read_b64_tr_b16 a[6:7], v188 offset:25600
    v_mfma_f32_16x16x32_bf16 v[36:39], a[60:63], a[116:119], v[36:39]
    ds_read_b64_tr_b16 a[8:9], v189 offset:16384
    v_mfma_f32_16x16x32_bf16 v[68:71], a[56:59], a[120:123], v[68:71]
    ds_read_b64_tr_b16 a[10:11], v189 offset:17408
    v_mfma_f32_16x16x32_bf16 v[68:71], a[60:63], a[124:127], v[68:71]
    buffer_load_dwordx4 v205, s[28:31], s69 offen offset:1024 lds
    v_mfma_f32_16x16x32_bf16 v[100:103], a[56:59], a[128:131], v[100:103]
    ds_read_b64_tr_b16 a[12:13], v189 offset:24576
    ds_read_b64_tr_b16 a[14:15], v189 offset:25600
    v_mfma_f32_16x16x32_bf16 v[100:103], a[60:63], a[132:135], v[100:103]
    s_waitcnt lgkmcnt(6)
    ds_read_b64_tr_b16 a[16:17], v190 offset:16384
    v_mfma_f32_16x16x32_bf16 v[8:11], a[0:3], a[136:139], v[8:11]
    s_waitcnt lgkmcnt(5)
    ds_read_b64_tr_b16 a[18:19], v190 offset:17408
    v_mfma_f32_16x16x32_bf16 v[8:11], a[4:7], a[140:143], v[8:11]
    buffer_load_dwordx4 v206, s[28:31], s69 offen offset:2048 lds
    v_mfma_f32_16x16x32_bf16 v[40:43], a[0:3], a[144:147], v[40:43]
    s_add_u32 s79, s61, 32768
    ds_read_b64_tr_b16 a[20:21], v190 offset:24576
    v_mfma_f32_16x16x32_bf16 v[40:43], a[4:7], a[148:151], v[40:43]
    ds_read_b64_tr_b16 a[22:23], v190 offset:25600
    v_mfma_f32_16x16x32_bf16 v[72:75], a[0:3], a[152:155], v[72:75]
    ds_read_b128 a[164:167], v197 offset:8192
    v_mfma_f32_16x16x32_bf16 v[72:75], a[4:7], a[156:159], v[72:75]
    s_waitcnt lgkmcnt(7)
    buffer_load_dwordx4 v207, s[28:31], s69 offen offset:3072 lds
    v_mfma_f32_16x16x32_bf16 v[12:15], a[8:11], a[136:139], v[12:15]
    s_waitcnt lgkmcnt(5)
    s_add_u32 m0, s72, 90112
    ds_read_b64_tr_b16 a[24:25], v191 offset:16384
    v_mfma_f32_16x16x32_bf16 v[12:15], a[12:15], a[140:143], v[12:15]
    ds_read_b64_tr_b16 a[26:27], v191 offset:17408
    v_mfma_f32_16x16x32_bf16 v[44:47], a[8:11], a[144:147], v[44:47]
    ds_read_b64_tr_b16 a[28:29], v191 offset:24576
    v_mfma_f32_16x16x32_bf16 v[44:47], a[12:15], a[148:151], v[44:47]
    buffer_load_dwordx4 v200, s[24:27], s79 offen lds
    v_mfma_f32_16x16x32_bf16 v[76:79], a[8:11], a[152:155], v[76:79]
    ds_read_b64_tr_b16 a[30:31], v191 offset:25600
    v_mfma_f32_16x16x32_bf16 v[76:79], a[12:15], a[156:159], v[76:79]
    s_waitcnt lgkmcnt(6)
    ds_read_b64_tr_b16 a[32:33], v192 offset:16384
    v_mfma_f32_16x16x32_bf16 v[16:19], a[16:19], a[136:139], v[16:19]
    s_waitcnt lgkmcnt(6)
    ds_read_b64_tr_b16 a[34:35], v192 offset:17408
    v_mfma_f32_16x16x32_bf16 v[16:19], a[20:23], a[140:143], v[16:19]
    buffer_load_dwordx4 v201, s[24:27], s79 offen offset:1024 lds
    v_mfma_f32_16x16x32_bf16 v[48:51], a[16:19], a[144:147], v[48:51]
L_pg1:
    s_cbranch_execz L_pg5
    s_add_u32 s79, s62, 0
    ds_read_b64_tr_b16 a[36:37], v192 offset:24576
    v_mfma_f32_16x16x32_bf16 v[48:51], a[20:23], a[148:151], v[48:51]
    s_add_u32 m0, s72, 98304
    ds_read_b64_tr_b16 a[38:39], v192 offset:25600
    v_mfma_f32_16x16x32_bf16 v[80:83], a[16:19], a[152:155], v[80:83]
    s_waitcnt vmcnt(13)
    ds_read_b128 a[168:171], v196 offset:16384
    v_mfma_f32_16x16x32_bf16 v[80:83], a[20:23], a[156:159], v[80:83]
    s_waitcnt lgkmcnt(6)
    ds_read_b128 a[172:175], v197 offset:16384
    buffer_load_dwordx4 v200, s[24:27], s79 offen lds
    v_mfma_f32_16x16x32_bf16 v[20:23], a[24:27], a[136:139], v[20:23]
    s_waitcnt lgkmcnt(6)
    ds_read_b64_tr_b16 a[40:41], v193 offset:16384
    v_mfma_f32_16x16x32_bf16 v[20:23], a[28:31], a[140:143], v[20:23]
    ds_read_b64_tr_b16 a[42:43], v193 offset:17408
    v_mfma_f32_16x16x32_bf16 v[52:55], a[24:27], a[144:147], v[52:55]
    ds_read_b64_tr_b16 a[44:45], v193 offset:24576
    v_mfma_f32_16x16x32_bf16 v[52:55], a[28:31], a[148:151], v[52:55]
    buffer_load_dwordx4 v201, s[24:27], s79 offen offset:1024 lds
    v_mfma_f32_16x16x32_bf16 v[84:87], a[24:27], a[152:155], v[84:87]
    s_add_u32 s79, s62, 16384
    ds_read_b64_tr_b16 a[46:47], v193 offset:25600
    v_mfma_f32_16x16x32_bf16 v[84:87], a[28:31], a[156:159], v[84:87]
    s_waitcnt vmcnt(13) lgkmcnt(7)
    s_add_u32 m0, s72, 106496
    ds_read_b128 a[176:179], v196 offset:24576
    v_mfma_f32_16x16x32_bf16 v[24:27], a[32:35], a[136:139], v[24:27]
    s_waitcnt lgkmcnt(7)
    ds_read_b128 a[180:183], v197 offset:24576
    v_mfma_f32_16x16x32_bf16 v[24:27], a[36:39], a[140:143], v[24:27]
    s_waitcnt lgkmcnt(6)
    buffer_load_dwordx4 v200, s[24:27], s79 offen lds
    v_mfma_f32_16x16x32_bf16 v[56:59], a[32:35], a[144:147], v[56:59]
    ds_read_b64_tr_b16 a[48:49], v194 offset:16384
    v_mfma_f32_16x16x32_bf16 v[56:59], a[36:39], a[148:151], v[56:59]
    ds_read_b64_tr_b16 a[50:51], v194 offset:17408
    v_mfma_f32_16x16x32_bf16 v[88:91], a[32:35], a[152:155], v[88:91]
    ds_read_b64_tr_b16 a[52:53], v194 offset:24576
    ds_read_b64_tr_b16 a[54:55], v194 offset:25600
    v_mfma_f32_16x16x32_bf16 v[88:91], a[36:39], a[156:159], v[88:91]
    s_waitcnt lgkmcnt(7)
    buffer_load_dwordx4 v201, s[24:27], s79 offen offset:1024 lds
    v_mfma_f32_16x16x32_bf16 v[28:31], a[40:43], a[136:139], v[28:31]
    s_waitcnt lgkmcnt(6)
    s_add_u32 s79, s62, 32768
    ds_read_b64_tr_b16 a[56:57], v195 offset:16384
    v_mfma_f32_16x16x32_bf16 v[28:31], a[44:47], a[140:143], v[28:31]
    s_add_u32 m0, s72, 114688
    ds_read_b64_tr_b16 a[58:59], v195 offset:17408
    v_mfma_f32_16x16x32_bf16 v[60:63], a[40:43], a[144:147], v[60:63]
    ds_read_b64_tr_b16 a[60:61], v195 offset:24576
    v_mfma_f32_16x16x32_bf16 v[60:63], a[44:47], a[148:151], v[60:63]
    s_waitcnt lgkmcnt(7)
    ds_read_b64_tr_b16 a[62:63], v195 offset:25600
    buffer_load_dwordx4 v200, s[24:27], s79 offen lds
    v_mfma_f32_16x16x32_bf16 v[92:95], a[40:43], a[152:155], v[92:95]
    s_waitcnt vmcnt(14)
    ds_read_b128 a[184:187], v196 offset:32768
    v_mfma_f32_16x16x32_bf16 v[92:95], a[44:47], a[156:159], v[92:95]
    s_waitcnt lgkmcnt(7)
    ds_read_b128 a[188:191], v197 offset:32768
    v_mfma_f32_16x16x32_bf16 v[32:35], a[48:51], a[136:139], v[32:35]
    s_waitcnt lgkmcnt(6)
    v_mfma_f32_16x16x32_bf16 v[32:35], a[52:55], a[140:143], v[32:35]
    buffer_load_dwordx4 v201, s[24:27], s79 offen offset:1024 lds
    v_mfma_f32_16x16x32_bf16 v[64:67], a[48:51], a[144:147], v[64:67]
    s_waitcnt vmcnt(13)
    s_add_u32 m0, s73, 57344
    ds_read_b128 a[192:195], v196 offset:40960
    v_mfma_f32_16x16x32_bf16 v[64:67], a[52:55], a[148:151], v[64:67]
    ds_read_b128 a[196:199], v197 offset:40960
    v_mfma_f32_16x16x32_bf16 v[96:99], a[48:51], a[152:155], v[96:99]
    s_waitcnt lgkmcnt(0)
    s_add_u32 s80, s80, 1
    s_add_u32 s0, s0, s80
    s_barrier
    ds_read_b64_tr_b16 a[0:1], v188 offset:32768
    ds_read_b64_tr_b16 a[2:3], v188 offset:33792
    v_mfma_f32_16x16x32_bf16 v[96:99], a[52:55], a[156:159], v[96:99]
    buffer_load_dwordx4 v204, s[28:31], s70 offen lds
    ds_read_b64_tr_b16 a[4:5], v188 offset:40960
    v_mfma_f32_16x16x32_bf16 v[36:39], a[56:59], a[136:139], v[36:39]
    ds_read_b64_tr_b16 a[6:7], v188 offset:41984
    v_mov_b32 v116, s0
    v_mfma_f32_16x16x32_bf16 v[36:39], a[60:63], a[140:143], v[36:39]
    ds_read_b64_tr_b16 a[8:9], v189 offset:32768
    v_mov_b32 v117, s0
    v_mfma_f32_16x16x32_bf16 v[68:71], a[56:59], a[144:147], v[68:71]
    ds_read_b64_tr_b16 a[10:11], v189 offset:33792
    v_mov_b32 v118, s0
    v_mfma_f32_16x16x32_bf16 v[68:71], a[60:63], a[148:151], v[68:71]
    buffer_load_dwordx4 v205, s[28:31], s70 offen offset:1024 lds
    v_mov_b32 v119, s0
    v_mfma_f32_16x16x32_bf16 v[100:103], a[56:59], a[152:155], v[100:103]
    ds_read_b64_tr_b16 a[12:13], v189 offset:40960
    ds_read_b64_tr_b16 a[14:15], v189 offset:41984
    v_mfma_f32_16x16x32_bf16 v[100:103], a[60:63], a[156:159], v[100:103]
    s_waitcnt lgkmcnt(6)
    ds_read_b64_tr_b16 a[16:17], v190 offset:32768
    v_lshrrev_b32 v246, 1, v7
    v_mfma_f32_16x16x32_bf16 v[8:11], a[0:3], a[160:163], v[8:11]
    s_waitcnt lgkmcnt(5)
    ds_read_b64_tr_b16 a[18:19], v190 offset:33792
    v_add_u32 v250, s83, v246
    v_mfma_f32_16x16x32_bf16 v[8:11], a[4:7], a[164:167], v[8:11]
    buffer_load_dwordx4 v206, s[28:31], s70 offen offset:2048 lds
    v_add_u32 v246, s87, v246
    v_mfma_f32_16x16x32_bf16 v[40:43], a[0:3], a[168:171], v[40:43]
    s_add_u32 s79, s63, 0
    ds_read_b64_tr_b16 a[20:21], v190 offset:40960
    v_mul_u32_u24 v242, 1152, v250
    v_mfma_f32_16x16x32_bf16 v[40:43], a[4:7], a[172:175], v[40:43]
    ds_read_b64_tr_b16 a[22:23], v190 offset:41984
    v_mfma_f32_16x16x32_bf16 v[72:75], a[0:3], a[176:179], v[72:75]
    ds_read_b64_tr_b16 a[24:25], v191 offset:32768
    v_mfma_f32_16x16x32_bf16 v[72:75], a[4:7], a[180:183], v[72:75]
    s_waitcnt lgkmcnt(7)
    buffer_load_dwordx4 v207, s[28:31], s70 offen offset:3072 lds
    v_mfma_f32_16x16x32_bf16 v[12:15], a[8:11], a[160:163], v[12:15]
    s_waitcnt lgkmcnt(5)
    s_add_u32 m0, s72, 122880
    ds_read_b64_tr_b16 a[26:27], v191 offset:33792
    v_mfma_f32_16x16x32_bf16 v[12:15], a[12:15], a[164:167], v[12:15]
    ds_read_b64_tr_b16 a[28:29], v191 offset:40960
    v_mfma_f32_16x16x32_bf16 v[44:47], a[8:11], a[168:171], v[44:47]
    ds_read_b64_tr_b16 a[30:31], v191 offset:41984
    v_mfma_f32_16x16x32_bf16 v[44:47], a[12:15], a[172:175], v[44:47]
    buffer_load_dwordx4 v200, s[24:27], s79 offen lds
    v_mfma_f32_16x16x32_bf16 v[76:79], a[8:11], a[176:179], v[76:79]
    ds_read_b64_tr_b16 a[32:33], v192 offset:32768
    v_mfma_f32_16x16x32_bf16 v[76:79], a[12:15], a[180:183], v[76:79]
    s_waitcnt lgkmcnt(6)
    ds_read_b64_tr_b16 a[34:35], v192 offset:33792
    v_mfma_f32_16x16x32_bf16 v[16:19], a[16:19], a[160:163], v[16:19]
    s_waitcnt lgkmcnt(6)
    ds_read_b64_tr_b16 a[36:37], v192 offset:40960
    v_mfma_f32_16x16x32_bf16 v[16:19], a[20:23], a[164:167], v[16:19]
    buffer_load_dwordx4 v201, s[24:27], s79 offen offset:1024 lds
    v_mfma_f32_16x16x32_bf16 v[48:51], a[16:19], a[168:171], v[48:51]
    s_add_u32 s79, s63, 16384
    ds_read_b64_tr_b16 a[38:39], v192 offset:41984
    v_mfma_f32_16x16x32_bf16 v[48:51], a[20:23], a[172:175], v[48:51]
    s_waitcnt vmcnt(12)
    s_add_u32 m0, s72, 131072
    ds_read_b128 a[200:203], v196 offset:0
    v_mfma_f32_16x16x32_bf16 v[80:83], a[16:19], a[176:179], v[80:83]
    ds_read_b128 a[204:207], v197 offset:0
    v_mfma_f32_16x16x32_bf16 v[80:83], a[20:23], a[180:183], v[80:83]
    s_waitcnt lgkmcnt(6)
    buffer_load_dwordx4 v200, s[24:27], s79 offen lds
    v_mfma_f32_16x16x32_bf16 v[20:23], a[24:27], a[160:163], v[20:23]
    ds_read_b64_tr_b16 a[40:41], v193 offset:32768
    v_mfma_f32_16x16x32_bf16 v[20:23], a[28:31], a[164:167], v[20:23]
    ds_read_b64_tr_b16 a[42:43], v193 offset:33792
    v_mfma_f32_16x16x32_bf16 v[52:55], a[24:27], a[168:171], v[52:55]
    ds_read_b64_tr_b16 a[44:45], v193 offset:40960
    v_mfma_f32_16x16x32_bf16 v[52:55], a[28:31], a[172:175], v[52:55]
    buffer_load_dwordx4 v201, s[24:27], s79 offen offset:1024 lds
    v_mfma_f32_16x16x32_bf16 v[84:87], a[24:27], a[176:179], v[84:87]
    s_add_u32 s79, s63, 32768
    ds_read_b64_tr_b16 a[46:47], v193 offset:41984
    v_mfma_f32_16x16x32_bf16 v[84:87], a[28:31], a[180:183], v[84:87]
    s_waitcnt lgkmcnt(6)
    s_add_u32 m0, s72, 90112
    ds_read_b64_tr_b16 a[48:49], v194 offset:32768
    v_mfma_f32_16x16x32_bf16 v[24:27], a[32:35], a[160:163], v[24:27]
    ds_read_b64_tr_b16 a[50:51], v194 offset:33792
    v_mfma_f32_16x16x32_bf16 v[24:27], a[36:39], a[164:167], v[24:27]
    s_waitcnt lgkmcnt(6)
    buffer_load_dwordx4 v200, s[24:27], s79 offen lds
    v_mfma_f32_16x16x32_bf16 v[56:59], a[32:35], a[168:171], v[56:59]
    ds_read_b64_tr_b16 a[52:53], v194 offset:40960
    v_mfma_f32_16x16x32_bf16 v[56:59], a[36:39], a[172:175], v[56:59]
    ds_read_b64_tr_b16 a[54:55], v194 offset:41984
    v_mfma_f32_16x16x32_bf16 v[88:91], a[32:35], a[176:179], v[88:91]
    ds_read_b64_tr_b16 a[56:57], v195 offset:32768
    v_mfma_f32_16x16x32_bf16 v[88:91], a[36:39], a[180:183], v[88:91]
    s_waitcnt lgkmcnt(6)
    buffer_load_dwordx4 v201, s[24:27], s79 offen offset:1024 lds
    v_mfma_f32_16x16x32_bf16 v[28:31], a[40:43], a[160:163], v[28:31]
    s_waitcnt lgkmcnt(5)
    ds_read_b64_tr_b16 a[58:59], v195 offset:33792
    v_mfma_f32_16x16x32_bf16 v[28:31], a[44:47], a[164:167], v[28:31]
    ds_read_b64_tr_b16 a[60:61], v195 offset:40960
    v_mfma_f32_16x16x32_bf16 v[60:63], a[40:43], a[168:171], v[60:63]
    ds_read_b64_tr_b16 a[62:63], v195 offset:41984
    v_mfma_f32_16x16x32_bf16 v[60:63], a[44:47], a[172:175], v[60:63]
    s_waitcnt vmcnt(14)
    ds_read_b128 a[208:211], v196 offset:8192
    ds_read_b128 a[212:215], v197 offset:8192
    v_mfma_f32_16x16x32_bf16 v[92:95], a[40:43], a[176:179], v[92:95]
    s_waitcnt vmcnt(12)
    ds_read_b128 a[216:219], v196 offset:16384
    ds_read_b128 a[220:223], v197 offset:16384
    v_mfma_f32_16x16x32_bf16 v[92:95], a[44:47], a[180:183], v[92:95]
    s_waitcnt lgkmcnt(9)
    v_mfma_f32_16x16x32_bf16 v[32:35], a[48:51], a[160:163], v[32:35]
    s_waitcnt lgkmcnt(8)
    s_add_u32 m0, s73, 73728
    v_mfma_f32_16x16x32_bf16 v[32:35], a[52:55], a[164:167], v[32:35]
    s_waitcnt vmcnt(10)
    ds_read_b128 a[224:227], v196 offset:24576
    v_mfma_f32_16x16x32_bf16 v[64:67], a[48:51], a[168:171], v[64:67]
    ds_read_b128 a[228:231], v197 offset:24576
    v_mfma_f32_16x16x32_bf16 v[64:67], a[52:55], a[172:175], v[64:67]
    v_mfma_f32_16x16x32_bf16 v[96:99], a[48:51], a[176:179], v[96:99]
    s_waitcnt lgkmcnt(2)
    s_barrier
    ds_read_b64_tr_b16 a[0:1], v188 offset:0
    ds_read_b64_tr_b16 a[2:3], v188 offset:1024
    v_mfma_f32_16x16x32_bf16 v[96:99], a[52:55], a[180:183], v[96:99]
    buffer_load_dwordx4 v204, s[28:31], s71 offen lds
    ds_read_b64_tr_b16 a[4:5], v188 offset:8192
    v_mfma_f32_16x16x32_bf16 v[36:39], a[56:59], a[160:163], v[36:39]
    ds_read_b64_tr_b16 a[6:7], v188 offset:9216
    v_mfma_f32_16x16x32_bf16 v[36:39], a[60:63], a[164:167], v[36:39]
    ds_read_b64_tr_b16 a[8:9], v189 offset:0
    v_mfma_f32_16x16x32_bf16 v[68:71], a[56:59], a[168:171], v[68:71]
    ds_read_b64_tr_b16 a[10:11], v189 offset:1024
    v_mfma_f32_16x16x32_bf16 v[68:71], a[60:63], a[172:175], v[68:71]
    buffer_load_dwordx4 v205, s[28:31], s71 offen offset:1024 lds
    v_mfma_f32_16x16x32_bf16 v[100:103], a[56:59], a[176:179], v[100:103]
    ds_read_b64_tr_b16 a[12:13], v189 offset:8192
    ds_read_b64_tr_b16 a[14:15], v189 offset:9216
    v_mfma_f32_16x16x32_bf16 v[100:103], a[60:63], a[180:183], v[100:103]
    s_waitcnt lgkmcnt(6)
    ds_read_b64_tr_b16 a[16:17], v190 offset:0
    v_mfma_f32_16x16x32_bf16 v[8:11], a[0:3], a[184:187], v[8:11]
    s_waitcnt lgkmcnt(5)
    ds_read_b64_tr_b16 a[18:19], v190 offset:1024
    v_mfma_f32_16x16x32_bf16 v[8:11], a[4:7], a[188:191], v[8:11]
    buffer_load_dwordx4 v206, s[28:31], s71 offen offset:2048 lds
    v_mfma_f32_16x16x32_bf16 v[40:43], a[0:3], a[192:195], v[40:43]
    s_mov_b32 s76, 16384
    ds_read_b64_tr_b16 a[20:21], v190 offset:8192
    v_mfma_f32_16x16x32_bf16 v[40:43], a[4:7], a[196:199], v[40:43]
    ds_read_b64_tr_b16 a[22:23], v190 offset:9216
    v_mfma_f32_16x16x32_bf16 v[72:75], a[0:3], a[200:203], v[72:75]
    ds_read_b64_tr_b16 a[24:25], v191 offset:0
    v_mfma_f32_16x16x32_bf16 v[72:75], a[4:7], a[204:207], v[72:75]
    s_waitcnt lgkmcnt(7)
    buffer_load_dwordx4 v207, s[28:31], s71 offen offset:3072 lds
    v_mfma_f32_16x16x32_bf16 v[12:15], a[8:11], a[184:187], v[12:15]
    s_waitcnt lgkmcnt(5)
    s_add_u32 m0, s72, 16384
    ds_read_b64_tr_b16 a[26:27], v191 offset:1024
    v_mfma_f32_16x16x32_bf16 v[12:15], a[12:15], a[188:191], v[12:15]
    ds_read_b64_tr_b16 a[28:29], v191 offset:8192
    v_mfma_f32_16x16x32_bf16 v[44:47], a[8:11], a[192:195], v[44:47]
    ds_read_b64_tr_b16 a[30:31], v191 offset:9216
    v_mfma_f32_16x16x32_bf16 v[44:47], a[12:15], a[196:199], v[44:47]
    buffer_load_dwordx4 v228, s[32:35], s76 offen nt lds
    v_mfma_f32_16x16x32_bf16 v[76:79], a[8:11], a[200:203], v[76:79]
    s_mov_b32 s77, 8192
    ds_read_b64_tr_b16 a[32:33], v192 offset:0
    v_mfma_f32_16x16x32_bf16 v[76:79], a[12:15], a[204:207], v[76:79]
    s_waitcnt lgkmcnt(6)
    ds_read_b64_tr_b16 a[34:35], v192 offset:1024
    v_mfma_f32_16x16x32_bf16 v[16:19], a[16:19], a[184:187], v[16:19]
    s_waitcnt lgkmcnt(6)
    ds_read_b64_tr_b16 a[36:37], v192 offset:8192
    v_mfma_f32_16x16x32_bf16 v[16:19], a[20:23], a[188:191], v[16:19]
    buffer_load_dwordx4 v229, s[32:35], s76 offen offset:1024 nt lds
    s_mov_b64 exec, 0xff
    buffer_store_dwordx4 v[116:119], v248, s[44:47], s82 offen sc1
    s_mov_b64 exec, -1
    v_mfma_f32_16x16x32_bf16 v[48:51], a[16:19], a[192:195], v[48:51]
    s_add_u32 m0, s72, 147456
    ds_read_b64_tr_b16 a[38:39], v192 offset:9216
    v_mfma_f32_16x16x32_bf16 v[48:51], a[20:23], a[196:199], v[48:51]
    ds_read_b64_tr_b16 a[40:41], v193 offset:0
    v_mfma_f32_16x16x32_bf16 v[80:83], a[16:19], a[200:203], v[80:83]
    ds_read_b64_tr_b16 a[42:43], v193 offset:1024
    v_mfma_f32_16x16x32_bf16 v[80:83], a[20:23], a[204:207], v[80:83]
    s_waitcnt lgkmcnt(6)
    buffer_load_dwordx4 v230, s[36:39], s77 offen nt lds
    v_mfma_f32_16x16x32_bf16 v[20:23], a[24:27], a[184:187], v[20:23]
    s_mov_b32 s76, 24576
    ds_read_b64_tr_b16 a[44:45], v193 offset:8192
    v_mfma_f32_16x16x32_bf16 v[20:23], a[28:31], a[188:191], v[20:23]
    ds_read_b64_tr_b16 a[46:47], v193 offset:9216
    v_mfma_f32_16x16x32_bf16 v[52:55], a[24:27], a[192:195], v[52:55]
    ds_read_b64_tr_b16 a[48:49], v194 offset:0
    v_mfma_f32_16x16x32_bf16 v[52:55], a[28:31], a[196:199], v[52:55]
    buffer_load_dwordx4 v231, s[36:39], s77 offen offset:1024 nt lds
    v_mfma_f32_16x16x32_bf16 v[84:87], a[24:27], a[200:203], v[84:87]
    s_add_u32 m0, s72, 24576
    ds_read_b64_tr_b16 a[50:51], v194 offset:1024
    v_mfma_f32_16x16x32_bf16 v[84:87], a[28:31], a[204:207], v[84:87]
    s_waitcnt lgkmcnt(6)
    ds_read_b64_tr_b16 a[52:53], v194 offset:8192
    v_mfma_f32_16x16x32_bf16 v[24:27], a[32:35], a[184:187], v[24:27]
    ds_read_b64_tr_b16 a[54:55], v194 offset:9216
    v_mfma_f32_16x16x32_bf16 v[24:27], a[36:39], a[188:191], v[24:27]
    buffer_load_dwordx4 v228, s[32:35], s76 offen nt lds
    v_mfma_f32_16x16x32_bf16 v[56:59], a[32:35], a[192:195], v[56:59]
    ds_read_b64_tr_b16 a[56:57], v195 offset:0
    v_mfma_f32_16x16x32_bf16 v[56:59], a[36:39], a[196:199], v[56:59]
    ds_read_b64_tr_b16 a[58:59], v195 offset:1024
    v_mfma_f32_16x16x32_bf16 v[88:91], a[32:35], a[200:203], v[88:91]
    ds_read_b64_tr_b16 a[60:61], v195 offset:8192
    v_mfma_f32_16x16x32_bf16 v[88:91], a[36:39], a[204:207], v[88:91]
    s_waitcnt lgkmcnt(6)
    buffer_load_dwordx4 v229, s[32:35], s76 offen offset:1024 nt lds
    v_mfma_f32_16x16x32_bf16 v[28:31], a[40:43], a[184:187], v[28:31]
    s_mov_b32 s77, 16384
    ds_read_b64_tr_b16 a[62:63], v195 offset:9216
    v_mfma_f32_16x16x32_bf16 v[28:31], a[44:47], a[188:191], v[28:31]
    s_waitcnt vmcnt(15)
    ds_read_b128 a[232:235], v196 offset:32768
    v_mfma_f32_16x16x32_bf16 v[60:63], a[40:43], a[192:195], v[60:63]
    s_add_u32 m0, s72, 139264
    ds_read_b128 a[236:239], v197 offset:32768
    v_mfma_f32_16x16x32_bf16 v[60:63], a[44:47], a[196:199], v[60:63]
    s_waitcnt vmcnt(13)
    ds_read_b128 a[240:243], v196 offset:40960
    ds_read_b128 a[244:247], v197 offset:40960
    v_mfma_f32_16x16x32_bf16 v[92:95], a[40:43], a[200:203], v[92:95]
    s_waitcnt vmcnt(11)
    ds_read_b128 a[248:251], v196 offset:0
    ds_read_b128 a[252:255], v197 offset:0
    v_mfma_f32_16x16x32_bf16 v[92:95], a[44:47], a[204:207], v[92:95]
    s_waitcnt lgkmcnt(9)
    v_mfma_f32_16x16x32_bf16 v[32:35], a[48:51], a[184:187], v[32:35]
    v_mfma_f32_16x16x32_bf16 v[32:35], a[52:55], a[188:191], v[32:35]
    buffer_load_dwordx4 v230, s[36:39], s77 offen nt lds
    v_mfma_f32_16x16x32_bf16 v[64:67], a[48:51], a[192:195], v[64:67]
    v_mfma_f32_16x16x32_bf16 v[64:67], a[52:55], a[196:199], v[64:67]
    v_mfma_f32_16x16x32_bf16 v[96:99], a[48:51], a[200:203], v[96:99]
    s_waitcnt lgkmcnt(0)
    s_barrier
    ds_read_b64_tr_b16 a[0:1], v188 offset:16384
    ds_read_b64_tr_b16 a[2:3], v188 offset:17408
    v_mfma_f32_16x16x32_bf16 v[96:99], a[52:55], a[204:207], v[96:99]
    buffer_load_dwordx4 v231, s[36:39], s77 offen offset:1024 nt lds
    ds_read_b64_tr_b16 a[4:5], v188 offset:24576
    v_mfma_f32_16x16x32_bf16 v[36:39], a[56:59], a[184:187], v[36:39]
    ds_read_b64_tr_b16 a[6:7], v188 offset:25600
    ds_read_b64_tr_b16 a[8:9], v189 offset:16384
    v_mfma_f32_16x16x32_bf16 v[36:39], a[60:63], a[188:191], v[36:39]
    ds_read_b64_tr_b16 a[10:11], v189 offset:17408
    ds_read_b64_tr_b16 a[12:13], v189 offset:24576
    v_mfma_f32_16x16x32_bf16 v[68:71], a[56:59], a[192:195], v[68:71]
    ds_read_b64_tr_b16 a[14:15], v189 offset:25600
    ds_read_b64_tr_b16 a[16:17], v190 offset:16384
    v_mfma_f32_16x16x32_bf16 v[68:71], a[60:63], a[196:199], v[68:71]
    ds_read_b64_tr_b16 a[18:19], v190 offset:17408
    ds_read_b64_tr_b16 a[20:21], v190 offset:24576
    v_mfma_f32_16x16x32_bf16 v[100:103], a[56:59], a[200:203], v[100:103]
    ds_read_b64_tr_b16 a[22:23], v190 offset:25600
    ds_read_b64_tr_b16 a[24:25], v191 offset:16384
    v_mfma_f32_16x16x32_bf16 v[100:103], a[60:63], a[204:207], v[100:103]
    ds_read_b64_tr_b16 a[26:27], v191 offset:17408
    ds_read_b64_tr_b16 a[28:29], v191 offset:24576
    s_waitcnt lgkmcnt(13)
    v_mfma_f32_16x16x32_bf16 v[8:11], a[0:3], a[208:211], v[8:11]
    s_waitcnt lgkmcnt(11)
    ds_read_b64_tr_b16 a[30:31], v191 offset:25600
    ds_read_b64_tr_b16 a[32:33], v192 offset:16384
    v_mfma_f32_16x16x32_bf16 v[8:11], a[4:7], a[212:215], v[8:11]
    s_waitcnt lgkmcnt(11)
    ds_read_b64_tr_b16 a[34:35], v192 offset:17408
    ds_read_b64_tr_b16 a[36:37], v192 offset:24576
    v_mfma_f32_16x16x32_bf16 v[12:15], a[8:11], a[208:211], v[12:15]
    s_waitcnt lgkmcnt(11)
    ds_read_b64_tr_b16 a[38:39], v192 offset:25600
    ds_read_b64_tr_b16 a[40:41], v193 offset:16384
    v_mfma_f32_16x16x32_bf16 v[12:15], a[12:15], a[212:215], v[12:15]
    s_waitcnt lgkmcnt(11)
    ds_read_b64_tr_b16 a[42:43], v193 offset:17408
    ds_read_b64_tr_b16 a[44:45], v193 offset:24576
    v_mfma_f32_16x16x32_bf16 v[16:19], a[16:19], a[208:211], v[16:19]
    s_waitcnt vmcnt(9)
    s_barrier
    ds_read_b64_tr_b16 a[46:47], v193 offset:25600
    ds_read_b64_tr_b16 a[48:49], v194 offset:16384
    s_waitcnt lgkmcnt(13)
    v_mfma_f32_16x16x32_bf16 v[16:19], a[20:23], a[212:215], v[16:19]
    s_waitcnt lgkmcnt(11)
    ds_read_b64_tr_b16 a[50:51], v194 offset:17408
    ds_read_b64_tr_b16 a[52:53], v194 offset:24576
    v_mfma_f32_16x16x32_bf16 v[20:23], a[24:27], a[208:211], v[20:23]
    s_waitcnt lgkmcnt(11)
    ds_read_b64_tr_b16 a[54:55], v194 offset:25600
    ds_read_b64_tr_b16 a[56:57], v195 offset:16384
    v_mfma_f32_16x16x32_bf16 v[20:23], a[28:31], a[212:215], v[20:23]
    s_waitcnt lgkmcnt(11)
    ds_read_b64_tr_b16 a[58:59], v195 offset:17408
    ds_read_b64_tr_b16 a[60:61], v195 offset:24576
    v_mfma_f32_16x16x32_bf16 v[24:27], a[32:35], a[208:211], v[24:27]
    s_waitcnt lgkmcnt(11)
    ds_read_b64_tr_b16 a[62:63], v195 offset:25600
    ds_read_b64_tr_b16 a[64:65], v188 offset:32768
    v_mfma_f32_16x16x32_bf16 v[24:27], a[36:39], a[212:215], v[24:27]
    s_waitcnt lgkmcnt(11)
    ds_read_b64_tr_b16 a[66:67], v188 offset:33792
    ds_read_b64_tr_b16 a[68:69], v188 offset:40960
    v_mfma_f32_16x16x32_bf16 v[28:31], a[40:43], a[208:211], v[28:31]
    s_waitcnt lgkmcnt(11)
    s_mov_b32 s76, 32768
    ds_read_b64_tr_b16 a[70:71], v188 offset:41984
    ds_read_b64_tr_b16 a[72:73], v189 offset:32768
    v_mfma_f32_16x16x32_bf16 v[28:31], a[44:47], a[212:215], v[28:31]
    s_waitcnt lgkmcnt(11)
    ds_read_b64_tr_b16 a[74:75], v189 offset:33792
    ds_read_b64_tr_b16 a[76:77], v189 offset:40960
    v_mfma_f32_16x16x32_bf16 v[32:35], a[48:51], a[208:211], v[32:35]
    s_waitcnt lgkmcnt(11)
    s_add_u32 m0, s72, 32768
    ds_read_b64_tr_b16 a[78:79], v189 offset:41984
    ds_read_b64_tr_b16 a[80:81], v190 offset:32768
    v_mfma_f32_16x16x32_bf16 v[32:35], a[52:55], a[212:215], v[32:35]
    s_waitcnt lgkmcnt(11)
    ds_read_b64_tr_b16 a[82:83], v190 offset:33792
    ds_read_b64_tr_b16 a[84:85], v190 offset:40960
    v_mfma_f32_16x16x32_bf16 v[36:39], a[56:59], a[208:211], v[36:39]
    s_waitcnt lgkmcnt(11)
    ds_read_b64_tr_b16 a[86:87], v190 offset:41984
    ds_read_b64_tr_b16 a[88:89], v191 offset:32768
    v_mfma_f32_16x16x32_bf16 v[36:39], a[60:63], a[212:215], v[36:39]
    s_waitcnt lgkmcnt(11)
    ds_read_b64_tr_b16 a[90:91], v191 offset:33792
    ds_read_b64_tr_b16 a[92:93], v191 offset:40960
    v_mfma_f32_16x16x32_bf16 v[8:11], a[64:67], a[232:235], v[8:11]
    s_waitcnt lgkmcnt(11)
    ds_read_b64_tr_b16 a[94:95], v191 offset:41984
    ds_read_b64_tr_b16 a[96:97], v192 offset:32768
    v_mfma_f32_16x16x32_bf16 v[8:11], a[68:71], a[236:239], v[8:11]
    s_waitcnt lgkmcnt(11)
    ds_read_b64_tr_b16 a[98:99], v192 offset:33792
    buffer_load_dwordx4 v228, s[32:35], s76 offen nt lds
    v_mfma_f32_16x16x32_bf16 v[12:15], a[72:75], a[232:235], v[12:15]
    s_waitcnt lgkmcnt(10)
    ds_read_b64_tr_b16 a[100:101], v192 offset:40960
    ds_read_b64_tr_b16 a[102:103], v192 offset:41984
    v_mfma_f32_16x16x32_bf16 v[12:15], a[76:79], a[236:239], v[12:15]
    s_waitcnt lgkmcnt(10)
    ds_read_b64_tr_b16 a[104:105], v193 offset:32768
    ds_read_b64_tr_b16 a[106:107], v193 offset:33792
    v_mfma_f32_16x16x32_bf16 v[16:19], a[80:83], a[232:235], v[16:19]
    s_waitcnt lgkmcnt(10)
    ds_read_b64_tr_b16 a[108:109], v193 offset:40960
    ds_read_b64_tr_b16 a[110:111], v193 offset:41984
    v_mfma_f32_16x16x32_bf16 v[16:19], a[84:87], a[236:239], v[16:19]
    s_waitcnt lgkmcnt(10)
    ds_read_b64_tr_b16 a[112:113], v194 offset:32768
    ds_read_b64_tr_b16 a[114:115], v194 offset:33792
    buffer_load_dwordx4 v229, s[32:35], s76 offen offset:1024 nt lds
    v_mfma_f32_16x16x32_bf16 v[20:23], a[88:91], a[232:235], v[20:23]
    s_waitcnt lgkmcnt(10)
    ds_read_b64_tr_b16 a[116:117], v194 offset:40960
    ds_read_b64_tr_b16 a[118:119], v194 offset:41984
    v_mfma_f32_16x16x32_bf16 v[20:23], a[92:95], a[236:239], v[20:23]
    s_waitcnt lgkmcnt(10)
    ds_read_b64_tr_b16 a[120:121], v195 offset:32768
    ds_read_b64_tr_b16 a[122:123], v195 offset:33792
    v_mfma_f32_16x16x32_bf16 v[24:27], a[96:99], a[232:235], v[24:27]
    s_waitcnt lgkmcnt(10)
    ds_read_b64_tr_b16 a[124:125], v195 offset:40960
    ds_read_b64_tr_b16 a[126:127], v195 offset:41984
    v_mfma_f32_16x16x32_bf16 v[24:27], a[100:103], a[236:239], v[24:27]
    s_waitcnt lgkmcnt(10)
    v_mul_f32 v8, s81, v8
    v_mul_f32 v9, s81, v9
    v_mfma_f32_16x16x32_bf16 v[28:31], a[104:107], a[232:235], v[28:31]
    s_waitcnt lgkmcnt(8)
    v_mul_f32 v10, s81, v10
    v_mul_f32 v11, s81, v11
    v_mfma_f32_16x16x32_bf16 v[28:31], a[108:111], a[236:239], v[28:31]
    s_waitcnt lgkmcnt(6)
    v_cvt_pk_bf16_f32 v116, v8, v9
    v_cvt_pk_bf16_f32 v117, v10, v11
    v_mfma_f32_16x16x32_bf16 v[32:35], a[112:115], a[232:235], v[32:35]
    s_waitcnt lgkmcnt(4)
    v_mul_f32 v12, s81, v12
    v_mul_f32 v13, s81, v13
    v_mfma_f32_16x16x32_bf16 v[32:35], a[116:119], a[236:239], v[32:35]
    s_waitcnt lgkmcnt(2)
    v_mul_f32 v14, s81, v14
    v_mul_f32 v15, s81, v15
    v_mfma_f32_16x16x32_bf16 v[36:39], a[120:123], a[232:235], v[36:39]
    s_waitcnt lgkmcnt(0)
    v_cvt_pk_bf16_f32 v118, v12, v13
    v_cvt_pk_bf16_f32 v119, v14, v15
    v_mfma_f32_16x16x32_bf16 v[36:39], a[124:127], a[236:239], v[36:39]
    v_permlane16_swap_b32 v116, v118
    v_mfma_f32_16x16x32_bf16 v[40:43], a[0:3], a[216:219], v[40:43]
    v_permlane16_swap_b32 v117, v119
    v_mfma_f32_16x16x32_bf16 v[40:43], a[4:7], a[220:223], v[40:43]
    v_mul_f32 v16, s81, v16
    v_mul_f32 v17, s81, v17
    v_mfma_f32_16x16x32_bf16 v[40:43], a[64:67], a[240:243], v[40:43]
    v_mul_f32 v18, s81, v18
    v_mul_f32 v19, s81, v19
    v_mfma_f32_16x16x32_bf16 v[40:43], a[68:71], a[244:247], v[40:43]
    v_cvt_pk_bf16_f32 v120, v16, v17
    v_cvt_pk_bf16_f32 v121, v18, v19
    v_mfma_f32_16x16x32_bf16 v[44:47], a[8:11], a[216:219], v[44:47]
    v_mul_f32 v20, s81, v20
    v_mul_f32 v21, s81, v21
    v_mfma_f32_16x16x32_bf16 v[44:47], a[12:15], a[220:223], v[44:47]
    v_mul_f32 v22, s81, v22
    v_mul_f32 v23, s81, v23
    v_mfma_f32_16x16x32_bf16 v[44:47], a[72:75], a[240:243], v[44:47]
    v_cvt_pk_bf16_f32 v122, v20, v21
    v_cvt_pk_bf16_f32 v123, v22, v23
    v_mfma_f32_16x16x32_bf16 v[44:47], a[76:79], a[244:247], v[44:47]
    v_permlane16_swap_b32 v120, v122
    v_mfma_f32_16x16x32_bf16 v[48:51], a[16:19], a[216:219], v[48:51]
    v_permlane16_swap_b32 v121, v123
    v_mfma_f32_16x16x32_bf16 v[48:51], a[20:23], a[220:223], v[48:51]
    v_mul_f32 v24, s81, v24
    v_mul_f32 v25, s81, v25
    v_mfma_f32_16x16x32_bf16 v[48:51], a[80:83], a[240:243], v[48:51]
    s_mov_b32 s77, 24576
    v_mul_f32 v26, s81, v26
    v_mul_f32 v27, s81, v27
    v_mfma_f32_16x16x32_bf16 v[48:51], a[84:87], a[244:247], v[48:51]
    v_cvt_pk_bf16_f32 v124, v24, v25
    v_cvt_pk_bf16_f32 v125, v26, v27
    v_mfma_f32_16x16x32_bf16 v[52:55], a[24:27], a[216:219], v[52:55]
    s_add_u32 m0, s72, 131072
    v_mul_f32 v28, s81, v28
    v_mul_f32 v29, s81, v29
    v_mfma_f32_16x16x32_bf16 v[52:55], a[28:31], a[220:223], v[52:55]
    v_mul_f32 v30, s81, v30
    v_mul_f32 v31, s81, v31
    v_mfma_f32_16x16x32_bf16 v[52:55], a[88:91], a[240:243], v[52:55]
    v_cvt_pk_bf16_f32 v126, v28, v29
    v_cvt_pk_bf16_f32 v127, v30, v31
    v_mfma_f32_16x16x32_bf16 v[52:55], a[92:95], a[244:247], v[52:55]
    v_permlane16_swap_b32 v124, v126
    v_mfma_f32_16x16x32_bf16 v[56:59], a[32:35], a[216:219], v[56:59]
    v_permlane16_swap_b32 v125, v127
    v_mfma_f32_16x16x32_bf16 v[56:59], a[36:39], a[220:223], v[56:59]
    buffer_load_dwordx4 v230, s[36:39], s77 offen nt lds
    v_mul_f32 v32, s81, v32
    v_mfma_f32_16x16x32_bf16 v[56:59], a[96:99], a[240:243], v[56:59]
    v_mul_f32 v33, s81, v33
    v_mul_f32 v34, s81, v34
    v_mfma_f32_16x16x32_bf16 v[56:59], a[100:103], a[244:247], v[56:59]
    v_mul_f32 v35, s81, v35
    v_cvt_pk_bf16_f32 v128, v32, v33
    v_mfma_f32_16x16x32_bf16 v[60:63], a[40:43], a[216:219], v[60:63]
    v_cvt_pk_bf16_f32 v129, v34, v35
    v_mul_f32 v36, s81, v36
    v_mfma_f32_16x16x32_bf16 v[60:63], a[44:47], a[220:223], v[60:63]
    buffer_load_dwordx4 v231, s[36:39], s77 offen offset:1024 nt lds
    v_mul_f32 v37, s81, v37
    v_mfma_f32_16x16x32_bf16 v[60:63], a[104:107], a[240:243], v[60:63]
    v_mul_f32 v38, s81, v38
    v_mul_f32 v39, s81, v39
    v_mfma_f32_16x16x32_bf16 v[60:63], a[108:111], a[244:247], v[60:63]
    v_cvt_pk_bf16_f32 v130, v36, v37
    v_cvt_pk_bf16_f32 v131, v38, v39
    v_mfma_f32_16x16x32_bf16 v[64:67], a[48:51], a[216:219], v[64:67]
    s_barrier
    ds_read_b128 a[128:131], v216 offset:0
    ds_read_b128 a[132:135], v217 offset:0
    v_mfma_f32_16x16x32_bf16 v[64:67], a[52:55], a[220:223], v[64:67]
    ds_read_b128 a[136:139], v218 offset:0
    v_mul_f32 v40, s81, v40
    v_mfma_f32_16x16x32_bf16 v[64:67], a[112:115], a[240:243], v[64:67]
    ds_read_b128 a[140:143], v219 offset:0
    v_mul_f32 v41, s81, v41
    v_mfma_f32_16x16x32_bf16 v[64:67], a[116:119], a[244:247], v[64:67]
    ds_read_b128 a[144:147], v216 offset:4096
    v_mul_f32 v42, s81, v42
    v_mfma_f32_16x16x32_bf16 v[68:71], a[56:59], a[216:219], v[68:71]
    ds_read_b128 a[148:151], v217 offset:4096
    v_mul_f32 v43, s81, v43
    v_mfma_f32_16x16x32_bf16 v[68:71], a[60:63], a[220:223], v[68:71]
    ds_read_b128 a[152:155], v218 offset:4096
    v_cvt_pk_bf16_f32 v132, v40, v41
    v_mfma_f32_16x16x32_bf16 v[68:71], a[120:123], a[240:243], v[68:71]
    ds_read_b128 a[156:159], v219 offset:4096
    v_cvt_pk_bf16_f32 v133, v42, v43
    v_mfma_f32_16x16x32_bf16 v[68:71], a[124:127], a[244:247], v[68:71]
L_pg2:
    s_cbranch_execz L_pg6
    s_waitcnt lgkmcnt(7)
    v_permlane16_swap_b32 v128, v130
    v_mfma_f32_16x16x32_bf16 v[164:167], a[128:131], v[116:119], 0
    s_waitcnt lgkmcnt(6)
    v_permlane16_swap_b32 v129, v131
    v_mfma_f32_16x16x32_bf16 v[164:167], a[132:135], v[120:123], v[164:167]
    s_waitcnt lgkmcnt(5)
    v_mul_f32 v44, s81, v44
    v_mul_f32 v45, s81, v45
    v_mfma_f32_16x16x32_bf16 v[164:167], a[136:139], v[124:127], v[164:167]
    s_waitcnt lgkmcnt(4)
    v_mul_f32 v46, s81, v46
    v_mul_f32 v47, s81, v47
    v_mfma_f32_16x16x32_bf16 v[164:167], a[140:143], v[128:131], v[164:167]
    s_waitcnt lgkmcnt(3)
    v_cvt_pk_bf16_f32 v134, v44, v45
    v_cvt_pk_bf16_f32 v135, v46, v47
    v_mfma_f32_16x16x32_bf16 v[168:171], a[144:147], v[116:119], 0
    s_waitcnt lgkmcnt(2)
    v_permlane16_swap_b32 v132, v134
    v_mfma_f32_16x16x32_bf16 v[168:171], a[148:151], v[120:123], v[168:171]
    s_waitcnt lgkmcnt(1)
    v_permlane16_swap_b32 v133, v135
    v_mfma_f32_16x16x32_bf16 v[168:171], a[152:155], v[124:127], v[168:171]
    s_waitcnt lgkmcnt(0)
    s_mov_b32 s76, 40960
    v_mul_f32 v48, s81, v48
    v_mul_f32 v49, s81, v49
    v_mfma_f32_16x16x32_bf16 v[168:171], a[156:159], v[128:131], v[168:171]
    v_mul_f32 v50, s81, v50
    v_mul_f32 v51, s81, v51
    v_mfma_f32_16x16x32_bf16 v[72:75], a[0:3], a[224:227], v[72:75]
    s_add_u32 m0, s72, 40960
    v_cvt_pk_bf16_f32 v136, v48, v49
    v_cvt_pk_bf16_f32 v137, v50, v51
    v_mfma_f32_16x16x32_bf16 v[72:75], a[4:7], a[228:231], v[72:75]
    v_mul_f32 v52, s81, v52
    v_mul_f32 v53, s81, v53
    v_mfma_f32_16x16x32_bf16 v[72:75], a[64:67], a[248:251], v[72:75]
    v_mul_f32 v54, s81, v54
    v_mul_f32 v55, s81, v55
    v_mfma_f32_16x16x32_bf16 v[72:75], a[68:71], a[252:255], v[72:75]
    v_cvt_pk_bf16_f32 v138, v52, v53
    v_cvt_pk_bf16_f32 v139, v54, v55
    v_mfma_f32_16x16x32_bf16 v[76:79], a[8:11], a[224:227], v[76:79]
    v_permlane16_swap_b32 v136, v138
    v_mfma_f32_16x16x32_bf16 v[76:79], a[12:15], a[228:231], v[76:79]
    buffer_load_dwordx4 v228, s[32:35], s76 offen nt lds
    v_mul_f32 v56, s81, v56
    v_mfma_f32_16x16x32_bf16 v[76:79], a[72:75], a[248:251], v[76:79]
    v_permlane16_swap_b32 v137, v139
    v_mfma_f32_16x16x32_bf16 v[76:79], a[76:79], a[252:255], v[76:79]
    v_mul_f32 v57, s81, v57
    v_mul_f32 v58, s81, v58
    v_mfma_f32_16x16x32_bf16 v[80:83], a[16:19], a[224:227], v[80:83]
    v_mul_f32 v59, s81, v59
    v_cvt_pk_bf16_f32 v140, v56, v57
    v_mfma_f32_16x16x32_bf16 v[80:83], a[20:23], a[228:231], v[80:83]
    buffer_load_dwordx4 v229, s[32:35], s76 offen offset:1024 nt lds
    v_cvt_pk_bf16_f32 v141, v58, v59
    v_mfma_f32_16x16x32_bf16 v[80:83], a[80:83], a[248:251], v[80:83]
    v_mul_f32 v60, s81, v60
    v_mul_f32 v61, s81, v61
    v_mfma_f32_16x16x32_bf16 v[80:83], a[84:87], a[252:255], v[80:83]
    v_mul_f32 v62, s81, v62
    v_mul_f32 v63, s81, v63
    v_mfma_f32_16x16x32_bf16 v[84:87], a[24:27], a[224:227], v[84:87]
    v_cvt_pk_bf16_f32 v142, v60, v61
    v_cvt_pk_bf16_f32 v143, v62, v63
    v_mfma_f32_16x16x32_bf16 v[84:87], a[28:31], a[228:231], v[84:87]
    v_permlane16_swap_b32 v140, v142
    v_mfma_f32_16x16x32_bf16 v[84:87], a[88:91], a[248:251], v[84:87]
    v_permlane16_swap_b32 v141, v143
    v_mfma_f32_16x16x32_bf16 v[84:87], a[92:95], a[252:255], v[84:87]
    v_mul_f32 v64, s81, v64
    v_mul_f32 v65, s81, v65
    v_mfma_f32_16x16x32_bf16 v[88:91], a[32:35], a[224:227], v[88:91]
    v_mul_f32 v66, s81, v66
    v_mul_f32 v67, s81, v67
    v_mfma_f32_16x16x32_bf16 v[88:91], a[36:39], a[228:231], v[88:91]
    v_cvt_pk_bf16_f32 v144, v64, v65
    v_cvt_pk_bf16_f32 v145, v66, v67
    v_mfma_f32_16x16x32_bf16 v[88:91], a[96:99], a[248:251], v[88:91]
    v_mul_f32 v68, s81, v68
    v_mul_f32 v69, s81, v69
    v_mfma_f32_16x16x32_bf16 v[88:91], a[100:103], a[252:255], v[88:91]
    v_mul_f32 v70, s81, v70
    v_mul_f32 v71, s81, v71
    v_mfma_f32_16x16x32_bf16 v[92:95], a[40:43], a[224:227], v[92:95]
    v_cvt_pk_bf16_f32 v146, v68, v69
    v_cvt_pk_bf16_f32 v147, v70, v71
    v_mfma_f32_16x16x32_bf16 v[92:95], a[44:47], a[228:231], v[92:95]
    v_permlane16_swap_b32 v144, v146
    v_mfma_f32_16x16x32_bf16 v[92:95], a[104:107], a[248:251], v[92:95]
    v_permlane16_swap_b32 v145, v147
    v_mfma_f32_16x16x32_bf16 v[92:95], a[108:111], a[252:255], v[92:95]
    ds_read_b128 a[0:3], v216 offset:8192
    v_max3_f32 v0, v164, v165, v166
    v_mfma_f32_16x16x32_bf16 v[96:99], a[48:51], a[224:227], v[96:99]
    ds_read_b128 a[4:7], v217 offset:8192
    v_max3_f32 v0, v0, v167, v168
    v_mfma_f32_16x16x32_bf16 v[96:99], a[52:55], a[228:231], v[96:99]
    ds_read_b128 a[8:11], v218 offset:8192
    v_max3_f32 v0, v0, v169, v170
    v_mfma_f32_16x16x32_bf16 v[96:99], a[112:115], a[248:251], v[96:99]
    s_mov_b32 s77, 32768
    v_max_f32 v0, v0, v171
    v_mov_b32 v1, v0
    v_mfma_f32_16x16x32_bf16 v[96:99], a[116:119], a[252:255], v[96:99]
    ds_read_b128 a[12:15], v219 offset:8192
    v_mul_f32 v72, s81, v72
    v_mfma_f32_16x16x32_bf16 v[100:103], a[56:59], a[224:227], v[100:103]
    s_add_u32 m0, s72, 122880
    v_permlane16_swap_b32 v0, v1
    v_mfma_f32_16x16x32_bf16 v[100:103], a[60:63], a[228:231], v[100:103]
    v_max_f32 v0, v0, v1
    v_mov_b32 v1, v0
    v_mfma_f32_16x16x32_bf16 v[100:103], a[120:123], a[248:251], v[100:103]
    ds_read_b128 a[16:19], v216 offset:12288
    v_mul_f32 v73, s81, v73
    v_mfma_f32_16x16x32_bf16 v[100:103], a[124:127], a[252:255], v[100:103]
    v_permlane32_swap_b32 v0, v1
    v_mfma_f32_16x16x32_bf16 v[172:175], a[128:131], v[132:135], 0
    v_max_f32 v0, v0, v1
    v_sub_f32 v200, 0, v0
    v_mfma_f32_16x16x32_bf16 v[172:175], a[132:135], v[136:139], v[172:175]
    buffer_load_dwordx4 v230, s[36:39], s77 offen nt lds
    v_sub_f32 v201, 0, v0
    v_mfma_f32_16x16x32_bf16 v[172:175], a[136:139], v[140:143], v[172:175]
    v_sub_f32 v202, 0, v0
    v_sub_f32 v203, 0, v0
    v_mfma_f32_16x16x32_bf16 v[172:175], a[140:143], v[144:147], v[172:175]
    v_sub_f32 v164, v164, v0
    v_sub_f32 v165, v165, v0
    v_mfma_f32_16x16x32_bf16 v[176:179], a[144:147], v[132:135], 0
    v_sub_f32 v166, v166, v0
    v_sub_f32 v167, v167, v0
    v_mfma_f32_16x16x32_bf16 v[176:179], a[148:151], v[136:139], v[176:179]
    ds_read_b128 a[20:23], v217 offset:12288
    buffer_load_dwordx4 v231, s[36:39], s77 offen offset:1024 nt lds
    v_mfma_f32_16x16x32_bf16 v[176:179], a[152:155], v[140:143], v[176:179]
    v_exp_f32 v164, v164
    v_exp_f32 v165, v165
    v_exp_f32 v166, v166
    v_exp_f32 v167, v167
    v_mfma_f32_16x16x32_bf16 v[176:179], a[156:159], v[144:147], v[176:179]
    s_waitcnt lgkmcnt(1)
    ds_read_b128 a[24:27], v218 offset:12288
    v_cvt_pk_bf16_f32 v188, v164, v165
    v_cvt_pk_bf16_f32 v189, v166, v167
    v_mfma_f32_16x16x32_bf16 v[164:167], a[0:3], v[116:119], v[200:203]
    ds_read_b128 a[28:31], v219 offset:12288
    v_sub_f32 v168, v168, v0
    v_mfma_f32_16x16x32_bf16 v[164:167], a[4:7], v[120:123], v[164:167]
    v_sub_f32 v169, v169, v0
    v_sub_f32 v170, v170, v0
    v_mfma_f32_16x16x32_bf16 v[164:167], a[8:11], v[124:127], v[164:167]
    s_add_u32 s78, s52, 0
    ds_read_b64_tr_b16 a[32:33], v220 offset:57344
    ds_read_b64_tr_b16 a[34:35], v220 offset:61440
    v_sub_f32 v171, v171, v0
    v_exp_f32 v168, v168
    v_exp_f32 v169, v169
    v_exp_f32 v170, v170
    v_exp_f32 v171, v171
    v_mfma_f32_16x16x32_bf16 v[164:167], a[12:15], v[128:131], v[164:167]
    ds_read_b64_tr_b16 a[36:37], v221 offset:57344
    ds_read_b64_tr_b16 a[38:39], v221 offset:61440
    v_cvt_pk_bf16_f32 v190, v168, v169
    v_cvt_pk_bf16_f32 v191, v170, v171
    v_mfma_f32_16x16x32_bf16 v[168:171], a[16:19], v[116:119], v[200:203]
    s_waitcnt lgkmcnt(6)
    s_add_u32 m0, s72, 65536
    ds_read_b64_tr_b16 a[40:41], v222 offset:57344
    ds_read_b64_tr_b16 a[42:43], v222 offset:61440
    v_mfma_f32_16x16x32_bf16 v[168:171], a[20:23], v[120:123], v[168:171]
    s_waitcnt lgkmcnt(7)
    ds_read_b64_tr_b16 a[44:45], v223 offset:57344
    ds_read_b64_tr_b16 a[46:47], v223 offset:61440
    v_mfma_f32_16x16x32_bf16 v[168:171], a[24:27], v[124:127], v[168:171]
    s_waitcnt lgkmcnt(8)
    ds_read_b64_tr_b16 a[48:49], v224 offset:57344
    ds_read_b64_tr_b16 a[50:51], v224 offset:61440
    v_mfma_f32_16x16x32_bf16 v[168:171], a[28:31], v[128:131], v[168:171]
    ds_read_b64_tr_b16 a[52:53], v225 offset:57344
    ds_read_b64_tr_b16 a[54:55], v225 offset:61440
    v_mfma_f32_16x16x32_bf16 v[104:107], v[212:215], v[188:191], 0
    s_waitcnt lgkmcnt(10)
    ds_read_b64_tr_b16 a[56:57], v226 offset:57344
    ds_read_b64_tr_b16 a[58:59], v226 offset:61440
    v_mfma_f32_16x16x32_bf16 v[8:11], a[32:35], v[188:191], 0
    s_waitcnt lgkmcnt(10)
    ds_read_b64_tr_b16 a[60:61], v227 offset:57344
    ds_read_b64_tr_b16 a[62:63], v227 offset:61440
    buffer_load_dwordx4 v244, s[40:43], s78 offen lds
    v_mfma_f32_16x16x32_bf16 v[12:15], a[36:39], v[188:191], 0
    s_waitcnt lgkmcnt(10)
    v_mul_f32 v74, s81, v74
    v_mul_f32 v75, s81, v75
    v_mfma_f32_16x16x32_bf16 v[16:19], a[40:43], v[188:191], 0
    s_waitcnt lgkmcnt(8)
    v_cvt_pk_bf16_f32 v148, v72, v73
    v_cvt_pk_bf16_f32 v149, v74, v75
    v_mfma_f32_16x16x32_bf16 v[20:23], a[44:47], v[188:191], 0
    s_waitcnt lgkmcnt(6)
    v_mul_f32 v76, s81, v76
    v_mul_f32 v77, s81, v77
    v_mfma_f32_16x16x32_bf16 v[24:27], a[48:51], v[188:191], 0
    s_waitcnt lgkmcnt(4)
    buffer_load_dwordx4 v245, s[40:43], s78 offen offset:1024 lds
    v_mul_f32 v78, s81, v78
    v_mfma_f32_16x16x32_bf16 v[28:31], a[52:55], v[188:191], 0
    s_waitcnt lgkmcnt(2)
    s_mov_b32 s76, 49152
    v_mul_f32 v79, s81, v79
    v_cvt_pk_bf16_f32 v150, v76, v77
    v_cvt_pk_bf16_f32 v151, v78, v79
    v_mfma_f32_16x16x32_bf16 v[32:35], a[56:59], v[188:191], 0
    s_waitcnt lgkmcnt(0)
    v_permlane16_swap_b32 v148, v150
    v_permlane16_swap_b32 v149, v151
    v_mul_f32 v80, s81, v80
    v_mul_f32 v81, s81, v81
    v_mul_f32 v82, s81, v82
    v_mul_f32 v83, s81, v83
    v_cvt_pk_bf16_f32 v152, v80, v81
    v_cvt_pk_bf16_f32 v153, v82, v83
    v_mul_f32 v84, s81, v84
    v_mul_f32 v85, s81, v85
    v_mul_f32 v86, s81, v86
    v_mul_f32 v87, s81, v87
    v_cvt_pk_bf16_f32 v154, v84, v85
    v_cvt_pk_bf16_f32 v155, v86, v87
    v_mfma_f32_16x16x32_bf16 v[36:39], a[60:63], v[188:191], 0
    s_add_u32 m0, s72, 49152
    v_permlane16_swap_b32 v152, v154
    v_permlane16_swap_b32 v153, v155
    v_mul_f32 v88, s81, v88
    v_mul_f32 v89, s81, v89
    v_mul_f32 v90, s81, v90
    v_mul_f32 v91, s81, v91
    v_cvt_pk_bf16_f32 v156, v88, v89
    v_cvt_pk_bf16_f32 v157, v90, v91
    v_mul_f32 v92, s81, v92
    v_mul_f32 v93, s81, v93
    v_mul_f32 v94, s81, v94
    v_mul_f32 v95, s81, v95
    v_cvt_pk_bf16_f32 v158, v92, v93
    v_cvt_pk_bf16_f32 v159, v94, v95
    v_mfma_f32_16x16x32_bf16 v[180:183], a[128:131], v[148:151], 0
    v_permlane16_swap_b32 v156, v158
    v_permlane16_swap_b32 v157, v159
    v_mul_f32 v96, s81, v96
    v_mul_f32 v97, s81, v97
    v_mul_f32 v98, s81, v98
    v_mul_f32 v99, s81, v99
    v_cvt_pk_bf16_f32 v160, v96, v97
    v_cvt_pk_bf16_f32 v161, v98, v99
    v_mul_f32 v100, s81, v100
    v_mul_f32 v101, s81, v101
    v_mul_f32 v102, s81, v102
    v_mul_f32 v103, s81, v103
    v_cvt_pk_bf16_f32 v162, v100, v101
    v_cvt_pk_bf16_f32 v163, v102, v103
    v_mfma_f32_16x16x32_bf16 v[180:183], a[132:135], v[152:155], v[180:183]
    v_permlane16_swap_b32 v160, v162
    v_permlane16_swap_b32 v161, v163
    v_mfma_f32_16x16x32_bf16 v[180:183], a[136:139], v[156:159], v[180:183]
    v_max3_f32 v2, v172, v173, v174
    v_max3_f32 v2, v2, v175, v176
    v_mfma_f32_16x16x32_bf16 v[180:183], a[140:143], v[160:163], v[180:183]
    v_max3_f32 v2, v2, v177, v178
    v_max_f32 v2, v2, v179
    v_mfma_f32_16x16x32_bf16 v[184:187], a[144:147], v[148:151], 0
    buffer_load_dwordx4 v228, s[32:35], s76 offen nt lds
    v_mov_b32 v3, v2
    v_mfma_f32_16x16x32_bf16 v[184:187], a[148:151], v[152:155], v[184:187]
    s_nop 0
    v_permlane16_swap_b32 v2, v3
    v_max_f32 v2, v2, v3
    v_mov_b32 v3, v2
    v_mfma_f32_16x16x32_bf16 v[184:187], a[152:155], v[156:159], v[184:187]
    s_nop 0
    v_permlane32_swap_b32 v2, v3
    v_max_f32 v2, v2, v3
    v_sub_f32 v204, 0, v2
    v_sub_f32 v205, 0, v2
    v_sub_f32 v206, 0, v2
    v_sub_f32 v207, 0, v2
    v_sub_f32 v172, v172, v2
    v_sub_f32 v173, v173, v2
    v_sub_f32 v174, v174, v2
    v_sub_f32 v175, v175, v2
    v_exp_f32 v172, v172
    v_exp_f32 v173, v173
    v_exp_f32 v174, v174
    v_exp_f32 v175, v175
    v_mfma_f32_16x16x32_bf16 v[184:187], a[156:159], v[160:163], v[184:187]
    v_cvt_pk_bf16_f32 v192, v172, v173
    v_cvt_pk_bf16_f32 v193, v174, v175
    v_mfma_f32_16x16x32_bf16 v[172:175], a[0:3], v[132:135], v[204:207]
    buffer_load_dwordx4 v229, s[32:35], s76 offen offset:1024 nt lds
    v_sub_f32 v176, v176, v2
    v_mfma_f32_16x16x32_bf16 v[172:175], a[4:7], v[136:139], v[172:175]
    v_sub_f32 v177, v177, v2
    v_sub_f32 v178, v178, v2
    v_mfma_f32_16x16x32_bf16 v[172:175], a[8:11], v[140:143], v[172:175]
    v_sub_f32 v179, v179, v2
    v_exp_f32 v176, v176
    v_exp_f32 v177, v177
    v_exp_f32 v178, v178
    v_exp_f32 v179, v179
    v_mfma_f32_16x16x32_bf16 v[172:175], a[12:15], v[144:147], v[172:175]
    v_cvt_pk_bf16_f32 v194, v176, v177
    v_cvt_pk_bf16_f32 v195, v178, v179
    v_mfma_f32_16x16x32_bf16 v[176:179], a[16:19], v[132:135], v[204:207]
    v_max3_f32 v4, v180, v181, v182
    v_max3_f32 v4, v4, v183, v184
    v_mfma_f32_16x16x32_bf16 v[176:179], a[20:23], v[136:139], v[176:179]
    v_max3_f32 v4, v4, v185, v186
    v_max_f32 v4, v4, v187
    v_mfma_f32_16x16x32_bf16 v[176:179], a[24:27], v[140:143], v[176:179]
    v_mov_b32 v5, v4
    v_mfma_f32_16x16x32_bf16 v[176:179], a[28:31], v[144:147], v[176:179]
    s_nop 0
    v_permlane16_swap_b32 v4, v5
    v_mfma_f32_16x16x32_bf16 v[108:111], v[212:215], v[192:195], 0
    v_max_f32 v4, v4, v5
    v_mov_b32 v5, v4
    v_mfma_f32_16x16x32_bf16 v[40:43], a[32:35], v[192:195], 0
    s_nop 0
    v_permlane32_swap_b32 v4, v5
    v_mfma_f32_16x16x32_bf16 v[44:47], a[36:39], v[192:195], 0
    v_max_f32 v4, v4, v5
    v_sub_f32 v208, 0, v4
    v_mfma_f32_16x16x32_bf16 v[48:51], a[40:43], v[192:195], 0
    v_sub_f32 v209, 0, v4
    v_sub_f32 v210, 0, v4
    v_mfma_f32_16x16x32_bf16 v[52:55], a[44:47], v[192:195], 0
    v_sub_f32 v211, 0, v4
    v_sub_f32 v180, v180, v4
    v_mfma_f32_16x16x32_bf16 v[56:59], a[48:51], v[192:195], 0
    v_sub_f32 v181, v181, v4
    v_sub_f32 v182, v182, v4
    v_mfma_f32_16x16x32_bf16 v[60:63], a[52:55], v[192:195], 0
    v_sub_f32 v183, v183, v4
    v_sub_f32 v184, v184, v4
    v_mfma_f32_16x16x32_bf16 v[64:67], a[56:59], v[192:195], 0
    v_exp_f32 v180, v180
    v_exp_f32 v181, v181
    v_exp_f32 v182, v182
    v_exp_f32 v183, v183
    v_mfma_f32_16x16x32_bf16 v[68:71], a[60:63], v[192:195], 0
    s_waitcnt vmcnt(16)
    s_barrier
    v_cvt_pk_bf16_f32 v196, v180, v181
    v_cvt_pk_bf16_f32 v197, v182, v183
    v_mfma_f32_16x16x32_bf16 v[180:183], a[0:3], v[148:151], v[208:211]
    s_add_u32 s78, s52, 32768
    ds_read_b128 a[0:3], v216 offset:16384
    v_sub_f32 v185, v185, v4
    v_mfma_f32_16x16x32_bf16 v[180:183], a[4:7], v[152:155], v[180:183]
    ds_read_b128 a[4:7], v217 offset:16384
    v_sub_f32 v186, v186, v4
    v_mfma_f32_16x16x32_bf16 v[180:183], a[8:11], v[156:159], v[180:183]
    s_add_u32 m0, s72, 73728
    ds_read_b128 a[8:11], v218 offset:16384
    v_sub_f32 v187, v187, v4
    v_exp_f32 v184, v184
    v_exp_f32 v185, v185
    v_exp_f32 v186, v186
    v_exp_f32 v187, v187
    v_mfma_f32_16x16x32_bf16 v[180:183], a[12:15], v[160:163], v[180:183]
    ds_read_b128 a[12:15], v219 offset:16384
    v_cvt_pk_bf16_f32 v198, v184, v185
    v_cvt_pk_bf16_f32 v199, v186, v187
    v_mfma_f32_16x16x32_bf16 v[184:187], a[16:19], v[148:151], v[208:211]
    ds_read_b128 a[16:19], v216 offset:20480
    v_mfma_f32_16x16x32_bf16 v[184:187], a[20:23], v[152:155], v[184:187]
    ds_read_b128 a[20:23], v217 offset:20480
    v_mfma_f32_16x16x32_bf16 v[184:187], a[24:27], v[156:159], v[184:187]
    ds_read_b128 a[24:27], v218 offset:20480
    v_mfma_f32_16x16x32_bf16 v[184:187], a[28:31], v[160:163], v[184:187]
    buffer_load_dwordx4 v244, s[40:43], s78 offen lds
    ds_read_b128 a[28:31], v219 offset:20480
    v_mfma_f32_16x16x32_bf16 v[112:115], v[212:215], v[196:199], 0
    s_mov_b32 s77, 40960
    v_exp_f32 v164, v164
    v_mfma_f32_16x16x32_bf16 v[72:75], a[32:35], v[196:199], 0
    ds_read_b64_tr_b16 a[32:33], v220 offset:49152
    v_mfma_f32_16x16x32_bf16 v[76:79], a[36:39], v[196:199], 0
    ds_read_b64_tr_b16 a[34:35], v220 offset:53248
    v_mfma_f32_16x16x32_bf16 v[80:83], a[40:43], v[196:199], 0
    buffer_load_dwordx4 v245, s[40:43], s78 offen offset:1024 lds
    ds_read_b64_tr_b16 a[36:37], v221 offset:49152
    v_mfma_f32_16x16x32_bf16 v[84:87], a[44:47], v[196:199], 0
    s_add_u32 m0, s72, 155648
    ds_read_b64_tr_b16 a[38:39], v221 offset:53248
    v_mfma_f32_16x16x32_bf16 v[88:91], a[48:51], v[196:199], 0
    ds_read_b64_tr_b16 a[40:41], v222 offset:49152
    v_mfma_f32_16x16x32_bf16 v[92:95], a[52:55], v[196:199], 0
    ds_read_b64_tr_b16 a[42:43], v222 offset:53248
    v_mfma_f32_16x16x32_bf16 v[96:99], a[56:59], v[196:199], 0
    buffer_load_dwordx4 v230, s[36:39], s77 offen nt lds
    ds_read_b64_tr_b16 a[44:45], v223 offset:49152
    v_exp_f32 v165, v165
    v_exp_f32 v166, v166
    v_exp_f32 v167, v167
    v_mfma_f32_16x16x32_bf16 v[100:103], a[60:63], v[196:199], 0
    ds_read_b64_tr_b16 a[46:47], v223 offset:53248
    v_cvt_pk_bf16_f32 v188, v164, v165
    v_cvt_pk_bf16_f32 v189, v166, v167
    s_waitcnt lgkmcnt(8)
    v_mfma_f32_16x16x32_bf16 v[164:167], a[0:3], v[116:119], v[200:203]
    ds_read_b64_tr_b16 a[48:49], v224 offset:49152
    v_mfma_f32_16x16x32_bf16 v[164:167], a[4:7], v[120:123], v[164:167]
    ds_read_b64_tr_b16 a[50:51], v224 offset:53248
    v_mfma_f32_16x16x32_bf16 v[164:167], a[8:11], v[124:127], v[164:167]
    buffer_load_dwordx4 v231, s[36:39], s77 offen offset:1024 nt lds
    ds_read_b64_tr_b16 a[52:53], v225 offset:49152
    v_exp_f32 v168, v168
    v_exp_f32 v169, v169
    v_exp_f32 v170, v170
    v_exp_f32 v171, v171
    v_mfma_f32_16x16x32_bf16 v[164:167], a[12:15], v[128:131], v[164:167]
    ds_read_b64_tr_b16 a[54:55], v225 offset:53248
    v_cvt_pk_bf16_f32 v190, v168, v169
    v_cvt_pk_bf16_f32 v191, v170, v171
    v_mfma_f32_16x16x32_bf16 v[168:171], a[16:19], v[116:119], v[200:203]
    ds_read_b64_tr_b16 a[56:57], v226 offset:49152
    v_mfma_f32_16x16x32_bf16 v[168:171], a[20:23], v[120:123], v[168:171]
    ds_read_b64_tr_b16 a[58:59], v226 offset:53248
    v_mfma_f32_16x16x32_bf16 v[168:171], a[24:27], v[124:127], v[168:171]
    ds_read_b64_tr_b16 a[60:61], v227 offset:49152
    v_mfma_f32_16x16x32_bf16 v[168:171], a[28:31], v[128:131], v[168:171]
    ds_read_b64_tr_b16 a[62:63], v227 offset:53248
    v_mfma_f32_16x16x32_bf16 v[104:107], v[212:215], v[188:191], v[104:107]
    s_waitcnt lgkmcnt(8)
    v_exp_f32 v164, v164
    v_mfma_f32_16x16x32_bf16 v[8:11], a[32:35], v[188:191], v[8:11]
    v_exp_f32 v165, v165
    v_mfma_f32_16x16x32_bf16 v[12:15], a[36:39], v[188:191], v[12:15]
    v_exp_f32 v166, v166
    v_mfma_f32_16x16x32_bf16 v[16:19], a[40:43], v[188:191], v[16:19]
    v_exp_f32 v167, v167
    v_mfma_f32_16x16x32_bf16 v[20:23], a[44:47], v[188:191], v[20:23]
    s_waitcnt lgkmcnt(4)
    v_exp_f32 v168, v168
    v_mfma_f32_16x16x32_bf16 v[24:27], a[48:51], v[188:191], v[24:27]
    v_exp_f32 v169, v169
    v_mfma_f32_16x16x32_bf16 v[28:31], a[52:55], v[188:191], v[28:31]
    s_waitcnt lgkmcnt(2)
    v_exp_f32 v170, v170
    v_mfma_f32_16x16x32_bf16 v[32:35], a[56:59], v[188:191], v[32:35]
    s_waitcnt lgkmcnt(0)
    v_exp_f32 v172, v172
    v_exp_f32 v173, v173
    v_exp_f32 v174, v174
    v_exp_f32 v175, v175
    v_exp_f32 v171, v171
    v_mfma_f32_16x16x32_bf16 v[36:39], a[60:63], v[188:191], v[36:39]
    v_cvt_pk_bf16_f32 v192, v172, v173
    v_cvt_pk_bf16_f32 v193, v174, v175
    v_exp_f32 v180, v180
    v_mfma_f32_16x16x32_bf16 v[172:175], a[0:3], v[132:135], v[204:207]
    v_exp_f32 v181, v181
    v_mfma_f32_16x16x32_bf16 v[172:175], a[4:7], v[136:139], v[172:175]
    v_exp_f32 v182, v182
    v_mfma_f32_16x16x32_bf16 v[172:175], a[8:11], v[140:143], v[172:175]
    v_exp_f32 v176, v176
    v_exp_f32 v177, v177
    v_exp_f32 v178, v178
    v_exp_f32 v179, v179
    v_exp_f32 v183, v183
    v_mfma_f32_16x16x32_bf16 v[172:175], a[12:15], v[144:147], v[172:175]
    v_cvt_pk_bf16_f32 v194, v176, v177
    v_cvt_pk_bf16_f32 v195, v178, v179
    v_exp_f32 v184, v184
    v_mfma_f32_16x16x32_bf16 v[176:179], a[16:19], v[132:135], v[204:207]
    v_exp_f32 v185, v185
    v_mfma_f32_16x16x32_bf16 v[176:179], a[20:23], v[136:139], v[176:179]
    v_exp_f32 v186, v186
    v_mfma_f32_16x16x32_bf16 v[176:179], a[24:27], v[140:143], v[176:179]
    v_exp_f32 v187, v187
    v_mfma_f32_16x16x32_bf16 v[176:179], a[28:31], v[144:147], v[176:179]
    v_cvt_pk_bf16_f32 v196, v180, v181
    v_cvt_pk_bf16_f32 v197, v182, v183
    v_mfma_f32_16x16x32_bf16 v[108:111], v[212:215], v[192:195], v[108:111]
    v_exp_f32 v172, v172
    v_mfma_f32_16x16x32_bf16 v[40:43], a[32:35], v[192:195], v[40:43]
    s_mov_b32 s76, 57344
    v_exp_f32 v173, v173
    v_mfma_f32_16x16x32_bf16 v[44:47], a[36:39], v[192:195], v[44:47]
    v_exp_f32 v174, v174
    v_mfma_f32_16x16x32_bf16 v[48:51], a[40:43], v[192:195], v[48:51]
    s_add_u32 m0, s72, 0
    v_exp_f32 v175, v175
    v_mfma_f32_16x16x32_bf16 v[52:55], a[44:47], v[192:195], v[52:55]
    v_exp_f32 v176, v176
    v_mfma_f32_16x16x32_bf16 v[56:59], a[48:51], v[192:195], v[56:59]
    v_exp_f32 v177, v177
    v_mfma_f32_16x16x32_bf16 v[60:63], a[52:55], v[192:195], v[60:63]
    v_exp_f32 v178, v178
    v_mfma_f32_16x16x32_bf16 v[64:67], a[56:59], v[192:195], v[64:67]
    v_exp_f32 v179, v179
    v_mfma_f32_16x16x32_bf16 v[68:71], a[60:63], v[192:195], v[68:71]
    s_waitcnt vmcnt(16)
    s_barrier
    buffer_load_dwordx4 v228, s[32:35], s76 offen nt lds
    v_mfma_f32_16x16x32_bf16 v[180:183], a[0:3], v[148:151], v[208:211]
    s_add_u32 s78, s52, 65536
    ds_read_b128 a[0:3], v216 offset:24576
    v_cvt_pk_bf16_f32 v198, v184, v185
    v_mfma_f32_16x16x32_bf16 v[180:183], a[4:7], v[152:155], v[180:183]
    ds_read_b128 a[4:7], v217 offset:24576
    v_cvt_pk_bf16_f32 v199, v186, v187
    v_mfma_f32_16x16x32_bf16 v[180:183], a[8:11], v[156:159], v[180:183]
    ds_read_b128 a[8:11], v218 offset:24576
    v_cvt_pk_bf16_f32 v188, v164, v165
    v_mfma_f32_16x16x32_bf16 v[180:183], a[12:15], v[160:163], v[180:183]
    buffer_load_dwordx4 v229, s[32:35], s76 offen offset:1024 nt lds
    ds_read_b128 a[12:15], v219 offset:24576
    v_mfma_f32_16x16x32_bf16 v[184:187], a[16:19], v[148:151], v[208:211]
    s_add_u32 m0, s72, 81920
    ds_read_b128 a[16:19], v216 offset:28672
    v_cvt_pk_bf16_f32 v189, v166, v167
    v_mfma_f32_16x16x32_bf16 v[184:187], a[20:23], v[152:155], v[184:187]
    ds_read_b128 a[20:23], v217 offset:28672
    v_cvt_pk_bf16_f32 v190, v168, v169
    v_mfma_f32_16x16x32_bf16 v[184:187], a[24:27], v[156:159], v[184:187]
    ds_read_b128 a[24:27], v218 offset:28672
    v_cvt_pk_bf16_f32 v191, v170, v171
    v_mfma_f32_16x16x32_bf16 v[184:187], a[28:31], v[160:163], v[184:187]
    buffer_load_dwordx4 v244, s[40:43], s78 offen lds
    ds_read_b128 a[28:31], v219 offset:28672
    v_mfma_f32_16x16x32_bf16 v[112:115], v[212:215], v[196:199], v[112:115]
    s_mov_b32 s77, 49152
    v_mfma_f32_16x16x32_bf16 v[72:75], a[32:35], v[196:199], v[72:75]
    ds_read_b64_tr_b16 a[32:33], v220 offset:40960
    v_cvt_pk_bf16_f32 v192, v172, v173
    v_mfma_f32_16x16x32_bf16 v[76:79], a[36:39], v[196:199], v[76:79]
    ds_read_b64_tr_b16 a[34:35], v220 offset:45056
    v_cvt_pk_bf16_f32 v193, v174, v175
    v_mfma_f32_16x16x32_bf16 v[80:83], a[40:43], v[196:199], v[80:83]
    buffer_load_dwordx4 v245, s[40:43], s78 offen offset:1024 lds
    ds_read_b64_tr_b16 a[36:37], v221 offset:40960
    v_mfma_f32_16x16x32_bf16 v[84:87], a[44:47], v[196:199], v[84:87]
    s_add_u32 m0, s72, 147456
    ds_read_b64_tr_b16 a[38:39], v221 offset:45056
    v_cvt_pk_bf16_f32 v194, v176, v177
    v_mfma_f32_16x16x32_bf16 v[88:91], a[48:51], v[196:199], v[88:91]
    ds_read_b64_tr_b16 a[40:41], v222 offset:40960
    v_cvt_pk_bf16_f32 v195, v178, v179
    v_mfma_f32_16x16x32_bf16 v[92:95], a[52:55], v[196:199], v[92:95]
    ds_read_b64_tr_b16 a[42:43], v222 offset:45056
    v_mfma_f32_16x16x32_bf16 v[96:99], a[56:59], v[196:199], v[96:99]
    buffer_load_dwordx4 v230, s[36:39], s77 offen nt lds
    ds_read_b64_tr_b16 a[44:45], v223 offset:40960
    v_mfma_f32_16x16x32_bf16 v[100:103], a[60:63], v[196:199], v[100:103]
    ds_read_b64_tr_b16 a[46:47], v223 offset:45056
    s_waitcnt lgkmcnt(8)
    v_mfma_f32_16x16x32_bf16 v[164:167], a[0:3], v[116:119], v[200:203]
    ds_read_b64_tr_b16 a[48:49], v224 offset:40960
    v_mfma_f32_16x16x32_bf16 v[164:167], a[4:7], v[120:123], v[164:167]
    ds_read_b64_tr_b16 a[50:51], v224 offset:45056
    v_mfma_f32_16x16x32_bf16 v[164:167], a[8:11], v[124:127], v[164:167]
    buffer_load_dwordx4 v231, s[36:39], s77 offen offset:1024 nt lds
    ds_read_b64_tr_b16 a[52:53], v225 offset:40960
    v_mfma_f32_16x16x32_bf16 v[164:167], a[12:15], v[128:131], v[164:167]
    ds_read_b64_tr_b16 a[54:55], v225 offset:45056
    v_mfma_f32_16x16x32_bf16 v[168:171], a[16:19], v[116:119], v[200:203]
    ds_read_b64_tr_b16 a[56:57], v226 offset:40960
    v_mfma_f32_16x16x32_bf16 v[168:171], a[20:23], v[120:123], v[168:171]
    ds_read_b64_tr_b16 a[58:59], v226 offset:45056
    v_mfma_f32_16x16x32_bf16 v[168:171], a[24:27], v[124:127], v[168:171]
    ds_read_b64_tr_b16 a[60:61], v227 offset:40960
    v_mfma_f32_16x16x32_bf16 v[168:171], a[28:31], v[128:131], v[168:171]
    ds_read_b64_tr_b16 a[62:63], v227 offset:45056
    v_mfma_f32_16x16x32_bf16 v[104:107], v[212:215], v[188:191], v[104:107]
    s_waitcnt lgkmcnt(8)
    v_exp_f32 v164, v164
    v_mfma_f32_16x16x32_bf16 v[8:11], a[32:35], v[188:191], v[8:11]
    v_exp_f32 v165, v165
    v_mfma_f32_16x16x32_bf16 v[12:15], a[36:39], v[188:191], v[12:15]
    v_exp_f32 v166, v166
    v_mfma_f32_16x16x32_bf16 v[16:19], a[40:43], v[188:191], v[16:19]
    v_exp_f32 v167, v167
    v_mfma_f32_16x16x32_bf16 v[20:23], a[44:47], v[188:191], v[20:23]
    s_waitcnt lgkmcnt(4)
    v_exp_f32 v168, v168
    v_mfma_f32_16x16x32_bf16 v[24:27], a[48:51], v[188:191], v[24:27]
    v_exp_f32 v169, v169
    v_mfma_f32_16x16x32_bf16 v[28:31], a[52:55], v[188:191], v[28:31]
    s_waitcnt lgkmcnt(2)
    v_exp_f32 v170, v170
    v_mfma_f32_16x16x32_bf16 v[32:35], a[56:59], v[188:191], v[32:35]
    s_waitcnt lgkmcnt(0)
    v_exp_f32 v171, v171
    v_mfma_f32_16x16x32_bf16 v[36:39], a[60:63], v[188:191], v[36:39]
    v_exp_f32 v180, v180
    v_mfma_f32_16x16x32_bf16 v[172:175], a[0:3], v[132:135], v[204:207]
    v_exp_f32 v181, v181
    v_mfma_f32_16x16x32_bf16 v[172:175], a[4:7], v[136:139], v[172:175]
    v_exp_f32 v182, v182
    v_mfma_f32_16x16x32_bf16 v[172:175], a[8:11], v[140:143], v[172:175]
    v_exp_f32 v183, v183
    v_mfma_f32_16x16x32_bf16 v[172:175], a[12:15], v[144:147], v[172:175]
    v_exp_f32 v184, v184
    v_mfma_f32_16x16x32_bf16 v[176:179], a[16:19], v[132:135], v[204:207]
    v_exp_f32 v185, v185
    v_mfma_f32_16x16x32_bf16 v[176:179], a[20:23], v[136:139], v[176:179]
    v_exp_f32 v186, v186
    v_mfma_f32_16x16x32_bf16 v[176:179], a[24:27], v[140:143], v[176:179]
    v_exp_f32 v187, v187
    v_mfma_f32_16x16x32_bf16 v[176:179], a[28:31], v[144:147], v[176:179]
    v_cvt_pk_bf16_f32 v196, v180, v181
    v_cvt_pk_bf16_f32 v197, v182, v183
    v_mfma_f32_16x16x32_bf16 v[108:111], v[212:215], v[192:195], v[108:111]
    v_exp_f32 v172, v172
    v_mfma_f32_16x16x32_bf16 v[40:43], a[32:35], v[192:195], v[40:43]
    s_mov_b32 s76, 65536
    v_exp_f32 v173, v173
    v_mfma_f32_16x16x32_bf16 v[44:47], a[36:39], v[192:195], v[44:47]
    v_exp_f32 v174, v174
    v_mfma_f32_16x16x32_bf16 v[48:51], a[40:43], v[192:195], v[48:51]
    s_add_u32 m0, s72, 8192
    v_exp_f32 v175, v175
    v_mfma_f32_16x16x32_bf16 v[52:55], a[44:47], v[192:195], v[52:55]
    v_exp_f32 v176, v176
    v_mfma_f32_16x16x32_bf16 v[56:59], a[48:51], v[192:195], v[56:59]
    v_exp_f32 v177, v177
    v_mfma_f32_16x16x32_bf16 v[60:63], a[52:55], v[192:195], v[60:63]
    v_exp_f32 v178, v178
    v_mfma_f32_16x16x32_bf16 v[64:67], a[56:59], v[192:195], v[64:67]
    v_exp_f32 v179, v179
    v_mfma_f32_16x16x32_bf16 v[68:71], a[60:63], v[192:195], v[68:71]
    s_waitcnt vmcnt(18)
    s_barrier
    buffer_load_dwordx4 v228, s[32:35], s76 offen nt lds
    v_mfma_f32_16x16x32_bf16 v[180:183], a[0:3], v[148:151], v[208:211]
    s_add_u32 s78, s52, 98304
    ds_read_b128 a[0:3], v216 offset:32768
    v_cvt_pk_bf16_f32 v198, v184, v185
    v_mfma_f32_16x16x32_bf16 v[180:183], a[4:7], v[152:155], v[180:183]
L_pg3:
    s_cbranch_execz L_pg7
    ds_read_b128 a[4:7], v217 offset:32768
    v_cvt_pk_bf16_f32 v199, v186, v187
    v_mfma_f32_16x16x32_bf16 v[180:183], a[8:11], v[156:159], v[180:183]
    ds_read_b128 a[8:11], v218 offset:32768
    v_cvt_pk_bf16_f32 v188, v164, v165
    v_mfma_f32_16x16x32_bf16 v[180:183], a[12:15], v[160:163], v[180:183]
    buffer_load_dwordx4 v229, s[32:35], s76 offen offset:1024 nt lds
    ds_read_b128 a[12:15], v219 offset:32768
    v_mfma_f32_16x16x32_bf16 v[184:187], a[16:19], v[148:151], v[208:211]
    s_add_u32 m0, s72, 90112
    ds_read_b128 a[16:19], v216 offset:36864
    v_cvt_pk_bf16_f32 v189, v166, v167
    v_mfma_f32_16x16x32_bf16 v[184:187], a[20:23], v[152:155], v[184:187]
    ds_read_b128 a[20:23], v217 offset:36864
    v_cvt_pk_bf16_f32 v190, v168, v169
    v_mfma_f32_16x16x32_bf16 v[184:187], a[24:27], v[156:159], v[184:187]
    ds_read_b128 a[24:27], v218 offset:36864
    v_cvt_pk_bf16_f32 v191, v170, v171
    v_mfma_f32_16x16x32_bf16 v[184:187], a[28:31], v[160:163], v[184:187]
    buffer_load_dwordx4 v244, s[40:43], s78 offen lds
    ds_read_b128 a[28:31], v219 offset:36864
    v_mfma_f32_16x16x32_bf16 v[112:115], v[212:215], v[196:199], v[112:115]
    v_mfma_f32_16x16x32_bf16 v[72:75], a[32:35], v[196:199], v[72:75]
    ds_read_b64_tr_b16 a[32:33], v220 offset:32768
    v_cvt_pk_bf16_f32 v192, v172, v173
    v_mfma_f32_16x16x32_bf16 v[76:79], a[36:39], v[196:199], v[76:79]
    ds_read_b64_tr_b16 a[34:35], v220 offset:36864
    v_cvt_pk_bf16_f32 v193, v174, v175
    v_mfma_f32_16x16x32_bf16 v[80:83], a[40:43], v[196:199], v[80:83]
    buffer_load_dwordx4 v245, s[40:43], s78 offen offset:1024 lds
    ds_read_b64_tr_b16 a[36:37], v221 offset:32768
    v_mfma_f32_16x16x32_bf16 v[84:87], a[44:47], v[196:199], v[84:87]
    ds_read_b64_tr_b16 a[38:39], v221 offset:36864
    v_cvt_pk_bf16_f32 v194, v176, v177
    v_mfma_f32_16x16x32_bf16 v[88:91], a[48:51], v[196:199], v[88:91]
    ds_read_b64_tr_b16 a[40:41], v222 offset:32768
    v_cvt_pk_bf16_f32 v195, v178, v179
    v_mfma_f32_16x16x32_bf16 v[92:95], a[52:55], v[196:199], v[92:95]
    ds_read_b64_tr_b16 a[42:43], v222 offset:36864
    v_mfma_f32_16x16x32_bf16 v[96:99], a[56:59], v[196:199], v[96:99]
    ds_read_b64_tr_b16 a[44:45], v223 offset:32768
    v_mfma_f32_16x16x32_bf16 v[100:103], a[60:63], v[196:199], v[100:103]
    s_mov_b32 s77, 57344
    ds_read_b64_tr_b16 a[46:47], v223 offset:36864
    s_waitcnt lgkmcnt(8)
    v_mfma_f32_16x16x32_bf16 v[164:167], a[0:3], v[116:119], v[200:203]
    ds_read_b64_tr_b16 a[48:49], v224 offset:32768
    v_mfma_f32_16x16x32_bf16 v[164:167], a[4:7], v[120:123], v[164:167]
    s_add_u32 m0, s72, 139264
    ds_read_b64_tr_b16 a[50:51], v224 offset:36864
    v_mfma_f32_16x16x32_bf16 v[164:167], a[8:11], v[124:127], v[164:167]
    ds_read_b64_tr_b16 a[52:53], v225 offset:32768
    v_mfma_f32_16x16x32_bf16 v[164:167], a[12:15], v[128:131], v[164:167]
    ds_read_b64_tr_b16 a[54:55], v225 offset:36864
    v_mfma_f32_16x16x32_bf16 v[168:171], a[16:19], v[116:119], v[200:203]
    ds_read_b64_tr_b16 a[56:57], v226 offset:32768
    v_mfma_f32_16x16x32_bf16 v[168:171], a[20:23], v[120:123], v[168:171]
    ds_read_b64_tr_b16 a[58:59], v226 offset:36864
    v_mfma_f32_16x16x32_bf16 v[168:171], a[24:27], v[124:127], v[168:171]
    ds_read_b64_tr_b16 a[60:61], v227 offset:32768
    buffer_load_dwordx4 v230, s[36:39], s77 offen nt lds
    v_mfma_f32_16x16x32_bf16 v[168:171], a[28:31], v[128:131], v[168:171]
    ds_read_b64_tr_b16 a[62:63], v227 offset:36864
    v_mfma_f32_16x16x32_bf16 v[104:107], v[212:215], v[188:191], v[104:107]
    s_waitcnt lgkmcnt(8)
    v_exp_f32 v164, v164
    v_mfma_f32_16x16x32_bf16 v[8:11], a[32:35], v[188:191], v[8:11]
    v_exp_f32 v165, v165
    v_mfma_f32_16x16x32_bf16 v[12:15], a[36:39], v[188:191], v[12:15]
    v_exp_f32 v166, v166
    v_mfma_f32_16x16x32_bf16 v[16:19], a[40:43], v[188:191], v[16:19]
    v_exp_f32 v167, v167
    v_mfma_f32_16x16x32_bf16 v[20:23], a[44:47], v[188:191], v[20:23]
    s_waitcnt lgkmcnt(4)
    buffer_load_dwordx4 v231, s[36:39], s77 offen offset:1024 nt lds
    v_exp_f32 v168, v168
    v_mfma_f32_16x16x32_bf16 v[24:27], a[48:51], v[188:191], v[24:27]
    v_exp_f32 v169, v169
    v_mfma_f32_16x16x32_bf16 v[28:31], a[52:55], v[188:191], v[28:31]
    s_waitcnt lgkmcnt(2)
    v_exp_f32 v170, v170
    v_mfma_f32_16x16x32_bf16 v[32:35], a[56:59], v[188:191], v[32:35]
    s_waitcnt lgkmcnt(0)
    v_exp_f32 v171, v171
    v_mfma_f32_16x16x32_bf16 v[36:39], a[60:63], v[188:191], v[36:39]
    v_exp_f32 v180, v180
    v_mfma_f32_16x16x32_bf16 v[172:175], a[0:3], v[132:135], v[204:207]
    v_exp_f32 v181, v181
    v_mfma_f32_16x16x32_bf16 v[172:175], a[4:7], v[136:139], v[172:175]
    v_exp_f32 v182, v182
    v_mfma_f32_16x16x32_bf16 v[172:175], a[8:11], v[140:143], v[172:175]
    v_exp_f32 v183, v183
    v_mfma_f32_16x16x32_bf16 v[172:175], a[12:15], v[144:147], v[172:175]
    v_exp_f32 v184, v184
    v_mfma_f32_16x16x32_bf16 v[176:179], a[16:19], v[132:135], v[204:207]
    v_exp_f32 v185, v185
    v_mfma_f32_16x16x32_bf16 v[176:179], a[20:23], v[136:139], v[176:179]
    v_exp_f32 v186, v186
    v_mfma_f32_16x16x32_bf16 v[176:179], a[24:27], v[140:143], v[176:179]
    v_exp_f32 v187, v187
    v_mfma_f32_16x16x32_bf16 v[176:179], a[28:31], v[144:147], v[176:179]
    v_cvt_pk_bf16_f32 v196, v180, v181
    v_cvt_pk_bf16_f32 v197, v182, v183
    v_mfma_f32_16x16x32_bf16 v[108:111], v[212:215], v[192:195], v[108:111]
    v_exp_f32 v172, v172
    v_mfma_f32_16x16x32_bf16 v[40:43], a[32:35], v[192:195], v[40:43]
    s_add_u32 s78, s53, 0
    v_exp_f32 v173, v173
    v_mfma_f32_16x16x32_bf16 v[44:47], a[36:39], v[192:195], v[44:47]
    v_exp_f32 v174, v174
    v_mfma_f32_16x16x32_bf16 v[48:51], a[40:43], v[192:195], v[48:51]
    s_add_u32 m0, s72, 57344
    v_exp_f32 v175, v175
    v_mfma_f32_16x16x32_bf16 v[52:55], a[44:47], v[192:195], v[52:55]
    v_exp_f32 v176, v176
    v_mfma_f32_16x16x32_bf16 v[56:59], a[48:51], v[192:195], v[56:59]
    v_exp_f32 v177, v177
    v_mfma_f32_16x16x32_bf16 v[60:63], a[52:55], v[192:195], v[60:63]
    v_exp_f32 v178, v178
    v_mfma_f32_16x16x32_bf16 v[64:67], a[56:59], v[192:195], v[64:67]
    v_exp_f32 v179, v179
    v_mfma_f32_16x16x32_bf16 v[68:71], a[60:63], v[192:195], v[68:71]
    s_waitcnt vmcnt(20)
    s_barrier
    buffer_load_dwordx4 v244, s[40:43], s78 offen lds
    v_mfma_f32_16x16x32_bf16 v[180:183], a[0:3], v[148:151], v[208:211]
    s_mov_b32 s76, 73728
    ds_read_b128 a[0:3], v216 offset:40960
    v_cvt_pk_bf16_f32 v198, v184, v185
    v_mfma_f32_16x16x32_bf16 v[180:183], a[4:7], v[152:155], v[180:183]
    ds_read_b128 a[4:7], v217 offset:40960
    v_cvt_pk_bf16_f32 v199, v186, v187
    v_mfma_f32_16x16x32_bf16 v[180:183], a[8:11], v[156:159], v[180:183]
    ds_read_b128 a[8:11], v218 offset:40960
    v_cvt_pk_bf16_f32 v188, v164, v165
    v_mfma_f32_16x16x32_bf16 v[180:183], a[12:15], v[160:163], v[180:183]
    buffer_load_dwordx4 v245, s[40:43], s78 offen offset:1024 lds
    ds_read_b128 a[12:15], v219 offset:40960
    v_mfma_f32_16x16x32_bf16 v[184:187], a[16:19], v[148:151], v[208:211]
    s_add_u32 m0, s72, 16384
    ds_read_b128 a[16:19], v216 offset:45056
    v_cvt_pk_bf16_f32 v189, v166, v167
    v_mfma_f32_16x16x32_bf16 v[184:187], a[20:23], v[152:155], v[184:187]
    ds_read_b128 a[20:23], v217 offset:45056
    v_cvt_pk_bf16_f32 v190, v168, v169
    v_mfma_f32_16x16x32_bf16 v[184:187], a[24:27], v[156:159], v[184:187]
    ds_read_b128 a[24:27], v218 offset:45056
    v_cvt_pk_bf16_f32 v191, v170, v171
    v_mfma_f32_16x16x32_bf16 v[184:187], a[28:31], v[160:163], v[184:187]
    buffer_load_dwordx4 v228, s[32:35], s76 offen nt lds
    ds_read_b128 a[28:31], v219 offset:45056
    v_mfma_f32_16x16x32_bf16 v[112:115], v[212:215], v[196:199], v[112:115]
    v_mfma_f32_16x16x32_bf16 v[72:75], a[32:35], v[196:199], v[72:75]
    ds_read_b64_tr_b16 a[32:33], v220 offset:24576
    v_cvt_pk_bf16_f32 v192, v172, v173
    v_mfma_f32_16x16x32_bf16 v[76:79], a[36:39], v[196:199], v[76:79]
    ds_read_b64_tr_b16 a[34:35], v220 offset:28672
    v_cvt_pk_bf16_f32 v193, v174, v175
    v_mfma_f32_16x16x32_bf16 v[80:83], a[40:43], v[196:199], v[80:83]
    buffer_load_dwordx4 v229, s[32:35], s76 offen offset:1024 nt lds
    ds_read_b64_tr_b16 a[36:37], v221 offset:24576
    v_mfma_f32_16x16x32_bf16 v[84:87], a[44:47], v[196:199], v[84:87]
    ds_read_b64_tr_b16 a[38:39], v221 offset:28672
    v_cvt_pk_bf16_f32 v194, v176, v177
    v_mfma_f32_16x16x32_bf16 v[88:91], a[48:51], v[196:199], v[88:91]
    ds_read_b64_tr_b16 a[40:41], v222 offset:24576
    v_cvt_pk_bf16_f32 v195, v178, v179
    v_mfma_f32_16x16x32_bf16 v[92:95], a[52:55], v[196:199], v[92:95]
    ds_read_b64_tr_b16 a[42:43], v222 offset:28672
    v_mfma_f32_16x16x32_bf16 v[96:99], a[56:59], v[196:199], v[96:99]
    ds_read_b64_tr_b16 a[44:45], v223 offset:24576
    v_mfma_f32_16x16x32_bf16 v[100:103], a[60:63], v[196:199], v[100:103]
    ds_read_b64_tr_b16 a[46:47], v223 offset:28672
    s_waitcnt lgkmcnt(8)
    v_mfma_f32_16x16x32_bf16 v[164:167], a[0:3], v[116:119], v[200:203]
    ds_read_b64_tr_b16 a[48:49], v224 offset:24576
    v_mfma_f32_16x16x32_bf16 v[164:167], a[4:7], v[120:123], v[164:167]
    ds_read_b64_tr_b16 a[50:51], v224 offset:28672
    v_mfma_f32_16x16x32_bf16 v[164:167], a[8:11], v[124:127], v[164:167]
    ds_read_b64_tr_b16 a[52:53], v225 offset:24576
    v_mfma_f32_16x16x32_bf16 v[164:167], a[12:15], v[128:131], v[164:167]
    ds_read_b64_tr_b16 a[54:55], v225 offset:28672
    v_mfma_f32_16x16x32_bf16 v[168:171], a[16:19], v[116:119], v[200:203]
    ds_read_b64_tr_b16 a[56:57], v226 offset:24576
    v_mfma_f32_16x16x32_bf16 v[168:171], a[20:23], v[120:123], v[168:171]
    s_mov_b32 s77, 65536
    ds_read_b64_tr_b16 a[58:59], v226 offset:28672
    v_mfma_f32_16x16x32_bf16 v[168:171], a[24:27], v[124:127], v[168:171]
    ds_read_b64_tr_b16 a[60:61], v227 offset:24576
    v_mfma_f32_16x16x32_bf16 v[168:171], a[28:31], v[128:131], v[168:171]
    s_add_u32 m0, s72, 131072
    ds_read_b64_tr_b16 a[62:63], v227 offset:28672
    v_mfma_f32_16x16x32_bf16 v[104:107], v[212:215], v[188:191], v[104:107]
    s_waitcnt lgkmcnt(8)
    v_exp_f32 v164, v164
    v_mfma_f32_16x16x32_bf16 v[8:11], a[32:35], v[188:191], v[8:11]
    v_exp_f32 v165, v165
    v_mfma_f32_16x16x32_bf16 v[12:15], a[36:39], v[188:191], v[12:15]
    v_exp_f32 v166, v166
    v_mfma_f32_16x16x32_bf16 v[16:19], a[40:43], v[188:191], v[16:19]
    v_exp_f32 v167, v167
    v_mfma_f32_16x16x32_bf16 v[20:23], a[44:47], v[188:191], v[20:23]
    s_waitcnt lgkmcnt(4)
    buffer_load_dwordx4 v230, s[36:39], s77 offen nt lds
    v_exp_f32 v168, v168
    v_mfma_f32_16x16x32_bf16 v[24:27], a[48:51], v[188:191], v[24:27]
    v_exp_f32 v169, v169
    v_mfma_f32_16x16x32_bf16 v[28:31], a[52:55], v[188:191], v[28:31]
    s_waitcnt lgkmcnt(2)
    v_exp_f32 v170, v170
    v_mfma_f32_16x16x32_bf16 v[32:35], a[56:59], v[188:191], v[32:35]
    s_waitcnt lgkmcnt(0)
    v_exp_f32 v171, v171
    v_mfma_f32_16x16x32_bf16 v[36:39], a[60:63], v[188:191], v[36:39]
    v_exp_f32 v180, v180
    v_mfma_f32_16x16x32_bf16 v[172:175], a[0:3], v[132:135], v[204:207]
    v_exp_f32 v181, v181
    v_mfma_f32_16x16x32_bf16 v[172:175], a[4:7], v[136:139], v[172:175]
    v_exp_f32 v182, v182
    v_mfma_f32_16x16x32_bf16 v[172:175], a[8:11], v[140:143], v[172:175]
    v_exp_f32 v183, v183
    v_mfma_f32_16x16x32_bf16 v[172:175], a[12:15], v[144:147], v[172:175]
    v_exp_f32 v184, v184
    v_mfma_f32_16x16x32_bf16 v[176:179], a[16:19], v[132:135], v[204:207]
    v_exp_f32 v185, v185
    v_mfma_f32_16x16x32_bf16 v[176:179], a[20:23], v[136:139], v[176:179]
    v_exp_f32 v186, v186
    v_mfma_f32_16x16x32_bf16 v[176:179], a[24:27], v[140:143], v[176:179]
    v_exp_f32 v187, v187
    v_mfma_f32_16x16x32_bf16 v[176:179], a[28:31], v[144:147], v[176:179]
    v_cvt_pk_bf16_f32 v196, v180, v181
    v_cvt_pk_bf16_f32 v197, v182, v183
    v_mfma_f32_16x16x32_bf16 v[108:111], v[212:215], v[192:195], v[108:111]
    v_exp_f32 v172, v172
    v_mfma_f32_16x16x32_bf16 v[40:43], a[32:35], v[192:195], v[40:43]
    v_exp_f32 v173, v173
    v_mfma_f32_16x16x32_bf16 v[44:47], a[36:39], v[192:195], v[44:47]
    v_exp_f32 v174, v174
    v_mfma_f32_16x16x32_bf16 v[48:51], a[40:43], v[192:195], v[48:51]
    v_exp_f32 v175, v175
    v_mfma_f32_16x16x32_bf16 v[52:55], a[44:47], v[192:195], v[52:55]
    v_exp_f32 v176, v176
    v_mfma_f32_16x16x32_bf16 v[56:59], a[48:51], v[192:195], v[56:59]
    s_add_u32 s78, s53, 32768
    v_exp_f32 v177, v177
    v_mfma_f32_16x16x32_bf16 v[60:63], a[52:55], v[192:195], v[60:63]
    v_exp_f32 v178, v178
    v_mfma_f32_16x16x32_bf16 v[64:67], a[56:59], v[192:195], v[64:67]
    v_exp_f32 v179, v179
    v_mfma_f32_16x16x32_bf16 v[68:71], a[60:63], v[192:195], v[68:71]
    s_waitcnt vmcnt(17)
    s_barrier
    buffer_load_dwordx4 v231, s[36:39], s77 offen offset:1024 nt lds
    v_mfma_f32_16x16x32_bf16 v[180:183], a[0:3], v[148:151], v[208:211]
    s_add_u32 m0, s72, 98304
    ds_read_b128 a[0:3], v216 offset:49152
    v_cvt_pk_bf16_f32 v198, v184, v185
    v_mfma_f32_16x16x32_bf16 v[180:183], a[4:7], v[152:155], v[180:183]
    ds_read_b128 a[4:7], v217 offset:49152
    v_cvt_pk_bf16_f32 v199, v186, v187
    v_mfma_f32_16x16x32_bf16 v[180:183], a[8:11], v[156:159], v[180:183]
    ds_read_b128 a[8:11], v218 offset:49152
    v_cvt_pk_bf16_f32 v188, v164, v165
    v_mfma_f32_16x16x32_bf16 v[180:183], a[12:15], v[160:163], v[180:183]
    buffer_load_dwordx4 v244, s[40:43], s78 offen lds
    ds_read_b128 a[12:15], v219 offset:49152
    v_mfma_f32_16x16x32_bf16 v[184:187], a[16:19], v[148:151], v[208:211]
    s_mov_b32 s76, 81920
    ds_read_b128 a[16:19], v216 offset:53248
    v_cvt_pk_bf16_f32 v189, v166, v167
    v_mfma_f32_16x16x32_bf16 v[184:187], a[20:23], v[152:155], v[184:187]
    ds_read_b128 a[20:23], v217 offset:53248
    v_cvt_pk_bf16_f32 v190, v168, v169
    v_mfma_f32_16x16x32_bf16 v[184:187], a[24:27], v[156:159], v[184:187]
    ds_read_b128 a[24:27], v218 offset:53248
    v_cvt_pk_bf16_f32 v191, v170, v171
    v_mfma_f32_16x16x32_bf16 v[184:187], a[28:31], v[160:163], v[184:187]
    buffer_load_dwordx4 v245, s[40:43], s78 offen offset:1024 lds
    ds_read_b128 a[28:31], v219 offset:53248
    v_mfma_f32_16x16x32_bf16 v[112:115], v[212:215], v[196:199], v[112:115]
    s_add_u32 m0, s72, 24576
    v_mfma_f32_16x16x32_bf16 v[72:75], a[32:35], v[196:199], v[72:75]
    ds_read_b64_tr_b16 a[32:33], v220 offset:57344
    v_cvt_pk_bf16_f32 v192, v172, v173
    v_mfma_f32_16x16x32_bf16 v[76:79], a[36:39], v[196:199], v[76:79]
    ds_read_b64_tr_b16 a[34:35], v220 offset:61440
    v_cvt_pk_bf16_f32 v193, v174, v175
    v_mfma_f32_16x16x32_bf16 v[80:83], a[40:43], v[196:199], v[80:83]
    buffer_load_dwordx4 v228, s[32:35], s76 offen nt lds
    ds_read_b64_tr_b16 a[36:37], v221 offset:57344
    v_mfma_f32_16x16x32_bf16 v[84:87], a[44:47], v[196:199], v[84:87]
    ds_read_b64_tr_b16 a[38:39], v221 offset:61440
    v_cvt_pk_bf16_f32 v194, v176, v177
    v_mfma_f32_16x16x32_bf16 v[88:91], a[48:51], v[196:199], v[88:91]
    ds_read_b64_tr_b16 a[40:41], v222 offset:57344
    v_cvt_pk_bf16_f32 v195, v178, v179
    v_mfma_f32_16x16x32_bf16 v[92:95], a[52:55], v[196:199], v[92:95]
    ds_read_b64_tr_b16 a[42:43], v222 offset:61440
    v_mfma_f32_16x16x32_bf16 v[96:99], a[56:59], v[196:199], v[96:99]
    buffer_load_dwordx4 v229, s[32:35], s76 offen offset:1024 nt lds
    ds_read_b64_tr_b16 a[44:45], v223 offset:57344
    v_mfma_f32_16x16x32_bf16 v[100:103], a[60:63], v[196:199], v[100:103]
    ds_read_b64_tr_b16 a[46:47], v223 offset:61440
    s_waitcnt lgkmcnt(8)
    v_mfma_f32_16x16x32_bf16 v[164:167], a[0:3], v[116:119], v[200:203]
    ds_read_b64_tr_b16 a[48:49], v224 offset:57344
    v_mfma_f32_16x16x32_bf16 v[164:167], a[4:7], v[120:123], v[164:167]
    ds_read_b64_tr_b16 a[50:51], v224 offset:61440
    v_mfma_f32_16x16x32_bf16 v[164:167], a[8:11], v[124:127], v[164:167]
    ds_read_b64_tr_b16 a[52:53], v225 offset:57344
    v_mfma_f32_16x16x32_bf16 v[164:167], a[12:15], v[128:131], v[164:167]
    ds_read_b64_tr_b16 a[54:55], v225 offset:61440
    v_mfma_f32_16x16x32_bf16 v[168:171], a[16:19], v[116:119], v[200:203]
    ds_read_b64_tr_b16 a[56:57], v226 offset:57344
    v_mfma_f32_16x16x32_bf16 v[168:171], a[20:23], v[120:123], v[168:171]
    ds_read_b64_tr_b16 a[58:59], v226 offset:61440
    v_mfma_f32_16x16x32_bf16 v[168:171], a[24:27], v[124:127], v[168:171]
    ds_read_b64_tr_b16 a[60:61], v227 offset:57344
    v_mfma_f32_16x16x32_bf16 v[168:171], a[28:31], v[128:131], v[168:171]
    ds_read_b64_tr_b16 a[62:63], v227 offset:61440
    v_mfma_f32_16x16x32_bf16 v[104:107], v[212:215], v[188:191], v[104:107]
    s_waitcnt lgkmcnt(8)
    v_exp_f32 v164, v164
    v_mfma_f32_16x16x32_bf16 v[8:11], a[32:35], v[188:191], v[8:11]
    v_exp_f32 v165, v165
    v_mfma_f32_16x16x32_bf16 v[12:15], a[36:39], v[188:191], v[12:15]
    v_exp_f32 v166, v166
    v_mfma_f32_16x16x32_bf16 v[16:19], a[40:43], v[188:191], v[16:19]
    v_exp_f32 v167, v167
    v_mfma_f32_16x16x32_bf16 v[20:23], a[44:47], v[188:191], v[20:23]
    s_waitcnt lgkmcnt(4)
    v_exp_f32 v168, v168
    v_mfma_f32_16x16x32_bf16 v[24:27], a[48:51], v[188:191], v[24:27]
    v_exp_f32 v169, v169
    v_mfma_f32_16x16x32_bf16 v[28:31], a[52:55], v[188:191], v[28:31]
    s_waitcnt lgkmcnt(2)
    v_exp_f32 v170, v170
    v_mfma_f32_16x16x32_bf16 v[32:35], a[56:59], v[188:191], v[32:35]
    s_waitcnt lgkmcnt(0)
    v_exp_f32 v171, v171
    v_mfma_f32_16x16x32_bf16 v[36:39], a[60:63], v[188:191], v[36:39]
    v_exp_f32 v180, v180
    v_mfma_f32_16x16x32_bf16 v[172:175], a[0:3], v[132:135], v[204:207]
    v_exp_f32 v181, v181
    v_mfma_f32_16x16x32_bf16 v[172:175], a[4:7], v[136:139], v[172:175]
    v_exp_f32 v182, v182
    v_mfma_f32_16x16x32_bf16 v[172:175], a[8:11], v[140:143], v[172:175]
    v_exp_f32 v183, v183
    v_mfma_f32_16x16x32_bf16 v[172:175], a[12:15], v[144:147], v[172:175]
    v_exp_f32 v184, v184
    v_mfma_f32_16x16x32_bf16 v[176:179], a[16:19], v[132:135], v[204:207]
    v_exp_f32 v185, v185
    v_mfma_f32_16x16x32_bf16 v[176:179], a[20:23], v[136:139], v[176:179]
    v_exp_f32 v186, v186
    v_mfma_f32_16x16x32_bf16 v[176:179], a[24:27], v[140:143], v[176:179]
    v_exp_f32 v187, v187
    v_mfma_f32_16x16x32_bf16 v[176:179], a[28:31], v[144:147], v[176:179]
    v_cvt_pk_bf16_f32 v196, v180, v181
    v_cvt_pk_bf16_f32 v197, v182, v183
    v_mfma_f32_16x16x32_bf16 v[108:111], v[212:215], v[192:195], v[108:111]
    v_exp_f32 v172, v172
    v_mfma_f32_16x16x32_bf16 v[40:43], a[32:35], v[192:195], v[40:43]
    s_mov_b32 s77, 73728
    v_exp_f32 v173, v173
    v_mfma_f32_16x16x32_bf16 v[44:47], a[36:39], v[192:195], v[44:47]
    v_exp_f32 v174, v174
    v_mfma_f32_16x16x32_bf16 v[48:51], a[40:43], v[192:195], v[48:51]
    s_add_u32 m0, s72, 155648
    v_exp_f32 v175, v175
    v_mfma_f32_16x16x32_bf16 v[52:55], a[44:47], v[192:195], v[52:55]
    v_exp_f32 v176, v176
    v_mfma_f32_16x16x32_bf16 v[56:59], a[48:51], v[192:195], v[56:59]
    v_exp_f32 v177, v177
    v_mfma_f32_16x16x32_bf16 v[60:63], a[52:55], v[192:195], v[60:63]
    v_exp_f32 v178, v178
    v_mfma_f32_16x16x32_bf16 v[64:67], a[56:59], v[192:195], v[64:67]
    v_exp_f32 v179, v179
    v_mfma_f32_16x16x32_bf16 v[68:71], a[60:63], v[192:195], v[68:71]
    s_waitcnt vmcnt(16)
    s_barrier
    buffer_load_dwordx4 v230, s[36:39], s77 offen nt lds
    v_mfma_f32_16x16x32_bf16 v[180:183], a[0:3], v[148:151], v[208:211]
    s_add_u32 s78, s53, 65536
    ds_read_b128 a[0:3], v216 offset:0
    v_cvt_pk_bf16_f32 v198, v184, v185
    v_mfma_f32_16x16x32_bf16 v[180:183], a[4:7], v[152:155], v[180:183]
    ds_read_b128 a[4:7], v217 offset:0
    v_cvt_pk_bf16_f32 v199, v186, v187
    v_mfma_f32_16x16x32_bf16 v[180:183], a[8:11], v[156:159], v[180:183]
    ds_read_b128 a[8:11], v218 offset:0
    v_cvt_pk_bf16_f32 v188, v164, v165
    v_mfma_f32_16x16x32_bf16 v[180:183], a[12:15], v[160:163], v[180:183]
    buffer_load_dwordx4 v231, s[36:39], s77 offen offset:1024 nt lds
    ds_read_b128 a[12:15], v219 offset:0
    v_mfma_f32_16x16x32_bf16 v[184:187], a[16:19], v[148:151], v[208:211]
    s_add_u32 m0, s72, 49152
    ds_read_b128 a[16:19], v216 offset:4096
    v_cvt_pk_bf16_f32 v189, v166, v167
    v_mfma_f32_16x16x32_bf16 v[184:187], a[20:23], v[152:155], v[184:187]
    ds_read_b128 a[20:23], v217 offset:4096
    v_cvt_pk_bf16_f32 v190, v168, v169
    v_mfma_f32_16x16x32_bf16 v[184:187], a[24:27], v[156:159], v[184:187]
    ds_read_b128 a[24:27], v218 offset:4096
    v_cvt_pk_bf16_f32 v191, v170, v171
    v_mfma_f32_16x16x32_bf16 v[184:187], a[28:31], v[160:163], v[184:187]
    buffer_load_dwordx4 v244, s[40:43], s78 offen lds
    ds_read_b128 a[28:31], v219 offset:4096
    v_mfma_f32_16x16x32_bf16 v[112:115], v[212:215], v[196:199], v[112:115]
    s_mov_b32 s76, 90112
    v_mfma_f32_16x16x32_bf16 v[72:75], a[32:35], v[196:199], v[72:75]
    ds_read_b64_tr_b16 a[32:33], v220 offset:49152
    v_cvt_pk_bf16_f32 v192, v172, v173
    v_mfma_f32_16x16x32_bf16 v[76:79], a[36:39], v[196:199], v[76:79]
    ds_read_b64_tr_b16 a[34:35], v220 offset:53248
    v_cvt_pk_bf16_f32 v193, v174, v175
    v_mfma_f32_16x16x32_bf16 v[80:83], a[40:43], v[196:199], v[80:83]
    buffer_load_dwordx4 v245, s[40:43], s78 offen offset:1024 lds
    ds_read_b64_tr_b16 a[36:37], v221 offset:49152
    v_mfma_f32_16x16x32_bf16 v[84:87], a[44:47], v[196:199], v[84:87]
    s_add_u32 m0, s72, 32768
    ds_read_b64_tr_b16 a[38:39], v221 offset:53248
    v_cvt_pk_bf16_f32 v194, v176, v177
    v_mfma_f32_16x16x32_bf16 v[88:91], a[48:51], v[196:199], v[88:91]
    ds_read_b64_tr_b16 a[40:41], v222 offset:49152
    v_cvt_pk_bf16_f32 v195, v178, v179
    v_mfma_f32_16x16x32_bf16 v[92:95], a[52:55], v[196:199], v[92:95]
    ds_read_b64_tr_b16 a[42:43], v222 offset:53248
    v_mfma_f32_16x16x32_bf16 v[96:99], a[56:59], v[196:199], v[96:99]
    buffer_load_dwordx4 v228, s[32:35], s76 offen nt lds
    ds_read_b64_tr_b16 a[44:45], v223 offset:49152
    v_mfma_f32_16x16x32_bf16 v[100:103], a[60:63], v[196:199], v[100:103]
    ds_read_b64_tr_b16 a[46:47], v223 offset:53248
    s_waitcnt lgkmcnt(8)
    v_mfma_f32_16x16x32_bf16 v[164:167], a[0:3], v[116:119], v[200:203]
    ds_read_b64_tr_b16 a[48:49], v224 offset:49152
    v_mfma_f32_16x16x32_bf16 v[164:167], a[4:7], v[120:123], v[164:167]
    ds_read_b64_tr_b16 a[50:51], v224 offset:53248
    v_mfma_f32_16x16x32_bf16 v[164:167], a[8:11], v[124:127], v[164:167]
    buffer_load_dwordx4 v229, s[32:35], s76 offen offset:1024 nt lds
    ds_read_b64_tr_b16 a[52:53], v225 offset:49152
    v_mfma_f32_16x16x32_bf16 v[164:167], a[12:15], v[128:131], v[164:167]
    ds_read_b64_tr_b16 a[54:55], v225 offset:53248
    v_mfma_f32_16x16x32_bf16 v[168:171], a[16:19], v[116:119], v[200:203]
    ds_read_b64_tr_b16 a[56:57], v226 offset:49152
    v_mfma_f32_16x16x32_bf16 v[168:171], a[20:23], v[120:123], v[168:171]
    ds_read_b64_tr_b16 a[58:59], v226 offset:53248
    v_mfma_f32_16x16x32_bf16 v[168:171], a[24:27], v[124:127], v[168:171]
    ds_read_b64_tr_b16 a[60:61], v227 offset:49152
    v_mfma_f32_16x16x32_bf16 v[168:171], a[28:31], v[128:131], v[168:171]
    ds_read_b64_tr_b16 a[62:63], v227 offset:53248
    v_mfma_f32_16x16x32_bf16 v[104:107], v[212:215], v[188:191], v[104:107]
    s_waitcnt lgkmcnt(8)
    v_exp_f32 v164, v164
    v_mfma_f32_16x16x32_bf16 v[8:11], a[32:35], v[188:191], v[8:11]
    v_exp_f32 v165, v165
    v_mfma_f32_16x16x32_bf16 v[12:15], a[36:39], v[188:191], v[12:15]
    v_exp_f32 v166, v166
    v_mfma_f32_16x16x32_bf16 v[16:19], a[40:43], v[188:191], v[16:19]
    v_exp_f32 v167, v167
    v_mfma_f32_16x16x32_bf16 v[20:23], a[44:47], v[188:191], v[20:23]
    s_waitcnt lgkmcnt(4)
    v_exp_f32 v168, v168
    v_mfma_f32_16x16x32_bf16 v[24:27], a[48:51], v[188:191], v[24:27]
    v_exp_f32 v169, v169
    v_mfma_f32_16x16x32_bf16 v[28:31], a[52:55], v[188:191], v[28:31]
    s_waitcnt lgkmcnt(2)
    v_exp_f32 v170, v170
    v_mfma_f32_16x16x32_bf16 v[32:35], a[56:59], v[188:191], v[32:35]
    s_waitcnt lgkmcnt(0)
    v_exp_f32 v171, v171
    v_mfma_f32_16x16x32_bf16 v[36:39], a[60:63], v[188:191], v[36:39]
    v_exp_f32 v180, v180
    v_mfma_f32_16x16x32_bf16 v[172:175], a[0:3], v[132:135], v[204:207]
    v_exp_f32 v181, v181
    v_mfma_f32_16x16x32_bf16 v[172:175], a[4:7], v[136:139], v[172:175]
    v_exp_f32 v182, v182
    v_mfma_f32_16x16x32_bf16 v[172:175], a[8:11], v[140:143], v[172:175]
    v_exp_f32 v183, v183
    v_mfma_f32_16x16x32_bf16 v[172:175], a[12:15], v[144:147], v[172:175]
    v_exp_f32 v184, v184
    v_mfma_f32_16x16x32_bf16 v[176:179], a[16:19], v[132:135], v[204:207]
    v_exp_f32 v185, v185
    v_mfma_f32_16x16x32_bf16 v[176:179], a[20:23], v[136:139], v[176:179]
    v_exp_f32 v186, v186
    v_mfma_f32_16x16x32_bf16 v[176:179], a[24:27], v[140:143], v[176:179]
    v_exp_f32 v187, v187
    v_mfma_f32_16x16x32_bf16 v[176:179], a[28:31], v[144:147], v[176:179]
    v_cvt_pk_bf16_f32 v196, v180, v181
    v_cvt_pk_bf16_f32 v197, v182, v183
    v_mfma_f32_16x16x32_bf16 v[108:111], v[212:215], v[192:195], v[108:111]
    v_exp_f32 v172, v172
    v_mfma_f32_16x16x32_bf16 v[40:43], a[32:35], v[192:195], v[40:43]
    s_mov_b32 s77, 81920
    v_exp_f32 v173, v173
    v_mfma_f32_16x16x32_bf16 v[44:47], a[36:39], v[192:195], v[44:47]
    v_exp_f32 v174, v174
    v_mfma_f32_16x16x32_bf16 v[48:51], a[40:43], v[192:195], v[48:51]
    s_add_u32 m0, s72, 147456
    v_exp_f32 v175, v175
    v_mfma_f32_16x16x32_bf16 v[52:55], a[44:47], v[192:195], v[52:55]
    v_exp_f32 v176, v176
    v_mfma_f32_16x16x32_bf16 v[56:59], a[48:51], v[192:195], v[56:59]
    v_exp_f32 v177, v177
    v_mfma_f32_16x16x32_bf16 v[60:63], a[52:55], v[192:195], v[60:63]
    v_exp_f32 v178, v178
    v_mfma_f32_16x16x32_bf16 v[64:67], a[56:59], v[192:195], v[64:67]
    v_exp_f32 v179, v179
    v_mfma_f32_16x16x32_bf16 v[68:71], a[60:63], v[192:195], v[68:71]
    s_waitcnt vmcnt(16)
    s_barrier
    buffer_load_dwordx4 v230, s[36:39], s77 offen nt lds
    v_mfma_f32_16x16x32_bf16 v[180:183], a[0:3], v[148:151], v[208:211]
    s_add_u32 s78, s53, 98304
    ds_read_b128 a[0:3], v216 offset:8192
    v_cvt_pk_bf16_f32 v198, v184, v185
    v_mfma_f32_16x16x32_bf16 v[180:183], a[4:7], v[152:155], v[180:183]
    ds_read_b128 a[4:7], v217 offset:8192
    v_cvt_pk_bf16_f32 v199, v186, v187
    v_mfma_f32_16x16x32_bf16 v[180:183], a[8:11], v[156:159], v[180:183]
    ds_read_b128 a[8:11], v218 offset:8192
    v_cvt_pk_bf16_f32 v188, v164, v165
    v_mfma_f32_16x16x32_bf16 v[180:183], a[12:15], v[160:163], v[180:183]
    buffer_load_dwordx4 v231, s[36:39], s77 offen offset:1024 nt lds
    ds_read_b128 a[12:15], v219 offset:8192
    v_mfma_f32_16x16x32_bf16 v[184:187], a[16:19], v[148:151], v[208:211]
    s_add_u32 m0, s72, 106496
    ds_read_b128 a[16:19], v216 offset:12288
    v_cvt_pk_bf16_f32 v189, v166, v167
    v_mfma_f32_16x16x32_bf16 v[184:187], a[20:23], v[152:155], v[184:187]
    ds_read_b128 a[20:23], v217 offset:12288
    v_cvt_pk_bf16_f32 v190, v168, v169
    v_mfma_f32_16x16x32_bf16 v[184:187], a[24:27], v[156:159], v[184:187]
    ds_read_b128 a[24:27], v218 offset:12288
    v_cvt_pk_bf16_f32 v191, v170, v171
    v_mfma_f32_16x16x32_bf16 v[184:187], a[28:31], v[160:163], v[184:187]
    buffer_load_dwordx4 v244, s[40:43], s78 offen lds
    ds_read_b128 a[28:31], v219 offset:12288
    v_mfma_f32_16x16x32_bf16 v[112:115], v[212:215], v[196:199], v[112:115]
    v_mfma_f32_16x16x32_bf16 v[72:75], a[32:35], v[196:199], v[72:75]
    ds_read_b64_tr_b16 a[32:33], v220 offset:40960
    v_cvt_pk_bf16_f32 v192, v172, v173
    v_mfma_f32_16x16x32_bf16 v[76:79], a[36:39], v[196:199], v[76:79]
    ds_read_b64_tr_b16 a[34:35], v220 offset:45056
    v_cvt_pk_bf16_f32 v193, v174, v175
    v_mfma_f32_16x16x32_bf16 v[80:83], a[40:43], v[196:199], v[80:83]
    buffer_load_dwordx4 v245, s[40:43], s78 offen offset:1024 lds
    ds_read_b64_tr_b16 a[36:37], v221 offset:40960
    v_mfma_f32_16x16x32_bf16 v[84:87], a[44:47], v[196:199], v[84:87]
    ds_read_b64_tr_b16 a[38:39], v221 offset:45056
    v_cvt_pk_bf16_f32 v194, v176, v177
    v_mfma_f32_16x16x32_bf16 v[88:91], a[48:51], v[196:199], v[88:91]
    ds_read_b64_tr_b16 a[40:41], v222 offset:40960
    v_cvt_pk_bf16_f32 v195, v178, v179
    v_mfma_f32_16x16x32_bf16 v[92:95], a[52:55], v[196:199], v[92:95]
    ds_read_b64_tr_b16 a[42:43], v222 offset:45056
    v_mfma_f32_16x16x32_bf16 v[96:99], a[56:59], v[196:199], v[96:99]
    ds_read_b64_tr_b16 a[44:45], v223 offset:40960
    v_mfma_f32_16x16x32_bf16 v[100:103], a[60:63], v[196:199], v[100:103]
    s_mov_b32 s76, 98304
    ds_read_b64_tr_b16 a[46:47], v223 offset:45056
    s_waitcnt lgkmcnt(8)
    v_mfma_f32_16x16x32_bf16 v[164:167], a[0:3], v[116:119], v[200:203]
    ds_read_b64_tr_b16 a[48:49], v224 offset:40960
    v_mfma_f32_16x16x32_bf16 v[164:167], a[4:7], v[120:123], v[164:167]
    s_add_u32 m0, s72, 0
    ds_read_b64_tr_b16 a[50:51], v224 offset:45056
    v_mfma_f32_16x16x32_bf16 v[164:167], a[8:11], v[124:127], v[164:167]
    ds_read_b64_tr_b16 a[52:53], v225 offset:40960
    v_mfma_f32_16x16x32_bf16 v[164:167], a[12:15], v[128:131], v[164:167]
    ds_read_b64_tr_b16 a[54:55], v225 offset:45056
    v_mfma_f32_16x16x32_bf16 v[168:171], a[16:19], v[116:119], v[200:203]
    ds_read_b64_tr_b16 a[56:57], v226 offset:40960
    v_mfma_f32_16x16x32_bf16 v[168:171], a[20:23], v[120:123], v[168:171]
    ds_read_b64_tr_b16 a[58:59], v226 offset:45056
    v_mfma_f32_16x16x32_bf16 v[168:171], a[24:27], v[124:127], v[168:171]
L_pg4:
    s_cbranch_execz L_warmed
    ds_read_b64_tr_b16 a[60:61], v227 offset:40960
    buffer_load_dwordx4 v228, s[32:35], s76 offen nt lds
    v_mfma_f32_16x16x32_bf16 v[168:171], a[28:31], v[128:131], v[168:171]
    ds_read_b64_tr_b16 a[62:63], v227 offset:45056
    v_mfma_f32_16x16x32_bf16 v[104:107], v[212:215], v[188:191], v[104:107]
    s_waitcnt lgkmcnt(8)
    v_exp_f32 v164, v164
    v_mfma_f32_16x16x32_bf16 v[8:11], a[32:35], v[188:191], v[8:11]
    v_exp_f32 v165, v165
    v_mfma_f32_16x16x32_bf16 v[12:15], a[36:39], v[188:191], v[12:15]
    v_exp_f32 v166, v166
    v_mfma_f32_16x16x32_bf16 v[16:19], a[40:43], v[188:191], v[16:19]
    v_exp_f32 v167, v167
    v_mfma_f32_16x16x32_bf16 v[20:23], a[44:47], v[188:191], v[20:23]
    s_waitcnt lgkmcnt(4)
    buffer_load_dwordx4 v229, s[32:35], s76 offen offset:1024 nt lds
    v_exp_f32 v168, v168
    v_mfma_f32_16x16x32_bf16 v[24:27], a[48:51], v[188:191], v[24:27]
    v_exp_f32 v169, v169
    v_mfma_f32_16x16x32_bf16 v[28:31], a[52:55], v[188:191], v[28:31]
    s_waitcnt lgkmcnt(2)
    v_exp_f32 v170, v170
    v_mfma_f32_16x16x32_bf16 v[32:35], a[56:59], v[188:191], v[32:35]
    s_waitcnt lgkmcnt(0)
    v_exp_f32 v171, v171
    v_mfma_f32_16x16x32_bf16 v[36:39], a[60:63], v[188:191], v[36:39]
    v_exp_f32 v180, v180
    v_mfma_f32_16x16x32_bf16 v[172:175], a[0:3], v[132:135], v[204:207]
    v_exp_f32 v181, v181
    v_mfma_f32_16x16x32_bf16 v[172:175], a[4:7], v[136:139], v[172:175]
    v_exp_f32 v182, v182
    v_mfma_f32_16x16x32_bf16 v[172:175], a[8:11], v[140:143], v[172:175]
    v_exp_f32 v183, v183
    v_mfma_f32_16x16x32_bf16 v[172:175], a[12:15], v[144:147], v[172:175]
    v_exp_f32 v184, v184
    v_mfma_f32_16x16x32_bf16 v[176:179], a[16:19], v[132:135], v[204:207]
    v_exp_f32 v185, v185
    v_mfma_f32_16x16x32_bf16 v[176:179], a[20:23], v[136:139], v[176:179]
    v_exp_f32 v186, v186
    v_mfma_f32_16x16x32_bf16 v[176:179], a[24:27], v[140:143], v[176:179]
    v_exp_f32 v187, v187
    v_mfma_f32_16x16x32_bf16 v[176:179], a[28:31], v[144:147], v[176:179]
    v_cvt_pk_bf16_f32 v196, v180, v181
    v_cvt_pk_bf16_f32 v197, v182, v183
    v_mfma_f32_16x16x32_bf16 v[108:111], v[212:215], v[192:195], v[108:111]
    v_exp_f32 v172, v172
    v_mfma_f32_16x16x32_bf16 v[40:43], a[32:35], v[192:195], v[40:43]
    s_mov_b32 s77, 90112
    v_exp_f32 v173, v173
    v_mfma_f32_16x16x32_bf16 v[44:47], a[36:39], v[192:195], v[44:47]
    v_exp_f32 v174, v174
    v_mfma_f32_16x16x32_bf16 v[48:51], a[40:43], v[192:195], v[48:51]
    s_add_u32 m0, s72, 139264
    v_exp_f32 v175, v175
    v_mfma_f32_16x16x32_bf16 v[52:55], a[44:47], v[192:195], v[52:55]
    v_exp_f32 v176, v176
    v_mfma_f32_16x16x32_bf16 v[56:59], a[48:51], v[192:195], v[56:59]
    v_exp_f32 v177, v177
    v_mfma_f32_16x16x32_bf16 v[60:63], a[52:55], v[192:195], v[60:63]
    v_exp_f32 v178, v178
    v_mfma_f32_16x16x32_bf16 v[64:67], a[56:59], v[192:195], v[64:67]
    v_exp_f32 v179, v179
    v_mfma_f32_16x16x32_bf16 v[68:71], a[60:63], v[192:195], v[68:71]
    s_waitcnt vmcnt(16)
    s_barrier
    buffer_load_dwordx4 v230, s[36:39], s77 offen nt lds
    v_mfma_f32_16x16x32_bf16 v[180:183], a[0:3], v[148:151], v[208:211]
    s_add_u32 s78, s54, 0
    ds_read_b128 a[0:3], v216 offset:16384
    v_cvt_pk_bf16_f32 v198, v184, v185
    v_mfma_f32_16x16x32_bf16 v[180:183], a[4:7], v[152:155], v[180:183]
    ds_read_b128 a[4:7], v217 offset:16384
    v_cvt_pk_bf16_f32 v199, v186, v187
    v_mfma_f32_16x16x32_bf16 v[180:183], a[8:11], v[156:159], v[180:183]
    ds_read_b128 a[8:11], v218 offset:16384
    v_cvt_pk_bf16_f32 v188, v164, v165
    v_mfma_f32_16x16x32_bf16 v[180:183], a[12:15], v[160:163], v[180:183]
    buffer_load_dwordx4 v231, s[36:39], s77 offen offset:1024 nt lds
    ds_read_b128 a[12:15], v219 offset:16384
    v_mfma_f32_16x16x32_bf16 v[184:187], a[16:19], v[148:151], v[208:211]
    s_add_u32 m0, s72, 40960
    ds_read_b128 a[16:19], v216 offset:20480
    v_cvt_pk_bf16_f32 v189, v166, v167
    v_mfma_f32_16x16x32_bf16 v[184:187], a[20:23], v[152:155], v[184:187]
    ds_read_b128 a[20:23], v217 offset:20480
    v_cvt_pk_bf16_f32 v190, v168, v169
    v_mfma_f32_16x16x32_bf16 v[184:187], a[24:27], v[156:159], v[184:187]
    ds_read_b128 a[24:27], v218 offset:20480
    v_cvt_pk_bf16_f32 v191, v170, v171
    v_mfma_f32_16x16x32_bf16 v[184:187], a[28:31], v[160:163], v[184:187]
    buffer_load_dwordx4 v244, s[40:43], s78 offen lds
    ds_read_b128 a[28:31], v219 offset:20480
    v_mfma_f32_16x16x32_bf16 v[112:115], v[212:215], v[196:199], v[112:115]
    v_mfma_f32_16x16x32_bf16 v[72:75], a[32:35], v[196:199], v[72:75]
    ds_read_b64_tr_b16 a[32:33], v220 offset:32768
    v_cvt_pk_bf16_f32 v192, v172, v173
    v_mfma_f32_16x16x32_bf16 v[76:79], a[36:39], v[196:199], v[76:79]
    ds_read_b64_tr_b16 a[34:35], v220 offset:36864
    v_cvt_pk_bf16_f32 v193, v174, v175
    v_mfma_f32_16x16x32_bf16 v[80:83], a[40:43], v[196:199], v[80:83]
    buffer_load_dwordx4 v245, s[40:43], s78 offen offset:1024 lds
    ds_read_b64_tr_b16 a[36:37], v221 offset:32768
    v_mfma_f32_16x16x32_bf16 v[84:87], a[44:47], v[196:199], v[84:87]
    ds_read_b64_tr_b16 a[38:39], v221 offset:36864
    v_cvt_pk_bf16_f32 v194, v176, v177
    v_mfma_f32_16x16x32_bf16 v[88:91], a[48:51], v[196:199], v[88:91]
    ds_read_b64_tr_b16 a[40:41], v222 offset:32768
    v_cvt_pk_bf16_f32 v195, v178, v179
    v_mfma_f32_16x16x32_bf16 v[92:95], a[52:55], v[196:199], v[92:95]
    ds_read_b64_tr_b16 a[42:43], v222 offset:36864
    v_mfma_f32_16x16x32_bf16 v[96:99], a[56:59], v[196:199], v[96:99]
    ds_read_b64_tr_b16 a[44:45], v223 offset:32768
    v_mfma_f32_16x16x32_bf16 v[100:103], a[60:63], v[196:199], v[100:103]
    ds_read_b64_tr_b16 a[46:47], v223 offset:36864
    s_waitcnt lgkmcnt(8)
    v_mfma_f32_16x16x32_bf16 v[164:167], a[0:3], v[116:119], v[200:203]
    ds_read_b64_tr_b16 a[48:49], v224 offset:32768
    v_mfma_f32_16x16x32_bf16 v[164:167], a[4:7], v[120:123], v[164:167]
    ds_read_b64_tr_b16 a[50:51], v224 offset:36864
    v_mfma_f32_16x16x32_bf16 v[164:167], a[8:11], v[124:127], v[164:167]
    ds_read_b64_tr_b16 a[52:53], v225 offset:32768
    v_mfma_f32_16x16x32_bf16 v[164:167], a[12:15], v[128:131], v[164:167]
    ds_read_b64_tr_b16 a[54:55], v225 offset:36864
    v_mfma_f32_16x16x32_bf16 v[168:171], a[16:19], v[116:119], v[200:203]
    ds_read_b64_tr_b16 a[56:57], v226 offset:32768
    v_mfma_f32_16x16x32_bf16 v[168:171], a[20:23], v[120:123], v[168:171]
    s_mov_b32 s76, 106496
    ds_read_b64_tr_b16 a[58:59], v226 offset:36864
    v_mfma_f32_16x16x32_bf16 v[168:171], a[24:27], v[124:127], v[168:171]
    ds_read_b64_tr_b16 a[60:61], v227 offset:32768
    v_mfma_f32_16x16x32_bf16 v[168:171], a[28:31], v[128:131], v[168:171]
    s_add_u32 m0, s72, 8192
    ds_read_b64_tr_b16 a[62:63], v227 offset:36864
    v_mfma_f32_16x16x32_bf16 v[104:107], v[212:215], v[188:191], v[104:107]
    s_waitcnt lgkmcnt(8)
    v_exp_f32 v164, v164
    v_mfma_f32_16x16x32_bf16 v[8:11], a[32:35], v[188:191], v[8:11]
    v_exp_f32 v165, v165
    v_mfma_f32_16x16x32_bf16 v[12:15], a[36:39], v[188:191], v[12:15]
    v_exp_f32 v166, v166
    v_mfma_f32_16x16x32_bf16 v[16:19], a[40:43], v[188:191], v[16:19]
    v_exp_f32 v167, v167
    v_mfma_f32_16x16x32_bf16 v[20:23], a[44:47], v[188:191], v[20:23]
    s_waitcnt lgkmcnt(4)
    buffer_load_dwordx4 v228, s[32:35], s76 offen nt lds
    v_exp_f32 v168, v168
    v_mfma_f32_16x16x32_bf16 v[24:27], a[48:51], v[188:191], v[24:27]
    v_exp_f32 v169, v169
    v_mfma_f32_16x16x32_bf16 v[28:31], a[52:55], v[188:191], v[28:31]
    s_waitcnt lgkmcnt(2)
    v_exp_f32 v170, v170
    v_mfma_f32_16x16x32_bf16 v[32:35], a[56:59], v[188:191], v[32:35]
    s_waitcnt lgkmcnt(0)
    v_exp_f32 v171, v171
    v_mfma_f32_16x16x32_bf16 v[36:39], a[60:63], v[188:191], v[36:39]
    v_exp_f32 v180, v180
    v_mfma_f32_16x16x32_bf16 v[172:175], a[0:3], v[132:135], v[204:207]
    v_exp_f32 v181, v181
    v_mfma_f32_16x16x32_bf16 v[172:175], a[4:7], v[136:139], v[172:175]
    v_exp_f32 v182, v182
    v_mfma_f32_16x16x32_bf16 v[172:175], a[8:11], v[140:143], v[172:175]
    v_exp_f32 v183, v183
    v_mfma_f32_16x16x32_bf16 v[172:175], a[12:15], v[144:147], v[172:175]
    v_exp_f32 v184, v184
    v_mfma_f32_16x16x32_bf16 v[176:179], a[16:19], v[132:135], v[204:207]
    v_exp_f32 v185, v185
    v_mfma_f32_16x16x32_bf16 v[176:179], a[20:23], v[136:139], v[176:179]
    v_exp_f32 v186, v186
    v_mfma_f32_16x16x32_bf16 v[176:179], a[24:27], v[140:143], v[176:179]
    v_exp_f32 v187, v187
    v_mfma_f32_16x16x32_bf16 v[176:179], a[28:31], v[144:147], v[176:179]
    v_cvt_pk_bf16_f32 v196, v180, v181
    v_cvt_pk_bf16_f32 v197, v182, v183
    v_mfma_f32_16x16x32_bf16 v[108:111], v[212:215], v[192:195], v[108:111]
    v_exp_f32 v172, v172
    v_mfma_f32_16x16x32_bf16 v[40:43], a[32:35], v[192:195], v[40:43]
    v_exp_f32 v173, v173
    v_mfma_f32_16x16x32_bf16 v[44:47], a[36:39], v[192:195], v[44:47]
    v_exp_f32 v174, v174
    v_mfma_f32_16x16x32_bf16 v[48:51], a[40:43], v[192:195], v[48:51]
    v_exp_f32 v175, v175
    v_mfma_f32_16x16x32_bf16 v[52:55], a[44:47], v[192:195], v[52:55]
    v_exp_f32 v176, v176
    v_mfma_f32_16x16x32_bf16 v[56:59], a[48:51], v[192:195], v[56:59]
    s_add_u32 s78, s54, 32768
    v_exp_f32 v177, v177
    v_mfma_f32_16x16x32_bf16 v[60:63], a[52:55], v[192:195], v[60:63]
    v_exp_f32 v178, v178
    v_mfma_f32_16x16x32_bf16 v[64:67], a[56:59], v[192:195], v[64:67]
    v_exp_f32 v179, v179
    v_mfma_f32_16x16x32_bf16 v[68:71], a[60:63], v[192:195], v[68:71]
    s_waitcnt vmcnt(15)
    s_barrier
    buffer_load_dwordx4 v229, s[32:35], s76 offen offset:1024 nt lds
    v_mfma_f32_16x16x32_bf16 v[180:183], a[0:3], v[148:151], v[208:211]
    s_add_u32 m0, s72, 114688
    ds_read_b128 a[0:3], v216 offset:24576
    v_cvt_pk_bf16_f32 v198, v184, v185
    v_mfma_f32_16x16x32_bf16 v[180:183], a[4:7], v[152:155], v[180:183]
    ds_read_b128 a[4:7], v217 offset:24576
    v_cvt_pk_bf16_f32 v199, v186, v187
    v_mfma_f32_16x16x32_bf16 v[180:183], a[8:11], v[156:159], v[180:183]
    ds_read_b128 a[8:11], v218 offset:24576
    v_cvt_pk_bf16_f32 v188, v164, v165
    v_mfma_f32_16x16x32_bf16 v[180:183], a[12:15], v[160:163], v[180:183]
    buffer_load_dwordx4 v244, s[40:43], s78 offen lds
    ds_read_b128 a[12:15], v219 offset:24576
    v_mfma_f32_16x16x32_bf16 v[184:187], a[16:19], v[148:151], v[208:211]
    s_mov_b32 s77, 98304
    ds_read_b128 a[16:19], v216 offset:28672
    v_cvt_pk_bf16_f32 v189, v166, v167
    v_mfma_f32_16x16x32_bf16 v[184:187], a[20:23], v[152:155], v[184:187]
    ds_read_b128 a[20:23], v217 offset:28672
    v_cvt_pk_bf16_f32 v190, v168, v169
    v_mfma_f32_16x16x32_bf16 v[184:187], a[24:27], v[156:159], v[184:187]
    ds_read_b128 a[24:27], v218 offset:28672
    v_cvt_pk_bf16_f32 v191, v170, v171
    v_mfma_f32_16x16x32_bf16 v[184:187], a[28:31], v[160:163], v[184:187]
    buffer_load_dwordx4 v245, s[40:43], s78 offen offset:1024 lds
    ds_read_b128 a[28:31], v219 offset:28672
    v_mfma_f32_16x16x32_bf16 v[112:115], v[212:215], v[196:199], v[112:115]
    s_add_u32 m0, s72, 131072
    v_mfma_f32_16x16x32_bf16 v[72:75], a[32:35], v[196:199], v[72:75]
    ds_read_b64_tr_b16 a[32:33], v220 offset:57344
    v_cvt_pk_bf16_f32 v192, v172, v173
    v_mfma_f32_16x16x32_bf16 v[76:79], a[36:39], v[196:199], v[76:79]
    ds_read_b64_tr_b16 a[34:35], v220 offset:61440
    v_cvt_pk_bf16_f32 v193, v174, v175
    v_mfma_f32_16x16x32_bf16 v[80:83], a[40:43], v[196:199], v[80:83]
    buffer_load_dwordx4 v230, s[36:39], s77 offen nt lds
    ds_read_b64_tr_b16 a[36:37], v221 offset:57344
    v_mfma_f32_16x16x32_bf16 v[84:87], a[44:47], v[196:199], v[84:87]
    ds_read_b64_tr_b16 a[38:39], v221 offset:61440
    v_cvt_pk_bf16_f32 v194, v176, v177
    v_mfma_f32_16x16x32_bf16 v[88:91], a[48:51], v[196:199], v[88:91]
    ds_read_b64_tr_b16 a[40:41], v222 offset:57344
    v_cvt_pk_bf16_f32 v195, v178, v179
    v_mfma_f32_16x16x32_bf16 v[92:95], a[52:55], v[196:199], v[92:95]
    ds_read_b64_tr_b16 a[42:43], v222 offset:61440
    v_mfma_f32_16x16x32_bf16 v[96:99], a[56:59], v[196:199], v[96:99]
    buffer_load_dwordx4 v231, s[36:39], s77 offen offset:1024 nt lds
    ds_read_b64_tr_b16 a[44:45], v223 offset:57344
    v_mfma_f32_16x16x32_bf16 v[100:103], a[60:63], v[196:199], v[100:103]
    ds_read_b64_tr_b16 a[46:47], v223 offset:61440
    s_waitcnt lgkmcnt(8)
    v_mfma_f32_16x16x32_bf16 v[164:167], a[0:3], v[116:119], v[200:203]
    ds_read_b64_tr_b16 a[48:49], v224 offset:57344
    v_mfma_f32_16x16x32_bf16 v[164:167], a[4:7], v[120:123], v[164:167]
    ds_read_b64_tr_b16 a[50:51], v224 offset:61440
    v_mfma_f32_16x16x32_bf16 v[164:167], a[8:11], v[124:127], v[164:167]
    ds_read_b64_tr_b16 a[52:53], v225 offset:57344
    v_mfma_f32_16x16x32_bf16 v[164:167], a[12:15], v[128:131], v[164:167]
    ds_read_b64_tr_b16 a[54:55], v225 offset:61440
    v_mfma_f32_16x16x32_bf16 v[168:171], a[16:19], v[116:119], v[200:203]
    ds_read_b64_tr_b16 a[56:57], v226 offset:57344
    v_mfma_f32_16x16x32_bf16 v[168:171], a[20:23], v[120:123], v[168:171]
    ds_read_b64_tr_b16 a[58:59], v226 offset:61440
    v_mfma_f32_16x16x32_bf16 v[168:171], a[24:27], v[124:127], v[168:171]
    ds_read_b64_tr_b16 a[60:61], v227 offset:57344
    v_mfma_f32_16x16x32_bf16 v[168:171], a[28:31], v[128:131], v[168:171]
    ds_read_b64_tr_b16 a[62:63], v227 offset:61440
    v_mfma_f32_16x16x32_bf16 v[104:107], v[212:215], v[188:191], v[104:107]
    s_waitcnt lgkmcnt(8)
    v_exp_f32 v164, v164
    v_mfma_f32_16x16x32_bf16 v[8:11], a[32:35], v[188:191], v[8:11]
    v_exp_f32 v165, v165
    v_mfma_f32_16x16x32_bf16 v[12:15], a[36:39], v[188:191], v[12:15]
    v_exp_f32 v166, v166
    v_mfma_f32_16x16x32_bf16 v[16:19], a[40:43], v[188:191], v[16:19]
    v_exp_f32 v167, v167
    v_mfma_f32_16x16x32_bf16 v[20:23], a[44:47], v[188:191], v[20:23]
    s_waitcnt lgkmcnt(4)
    v_exp_f32 v168, v168
    v_mfma_f32_16x16x32_bf16 v[24:27], a[48:51], v[188:191], v[24:27]
    v_exp_f32 v169, v169
    v_mfma_f32_16x16x32_bf16 v[28:31], a[52:55], v[188:191], v[28:31]
    s_waitcnt lgkmcnt(2)
    v_exp_f32 v170, v170
    v_mfma_f32_16x16x32_bf16 v[32:35], a[56:59], v[188:191], v[32:35]
    s_waitcnt lgkmcnt(0)
    v_exp_f32 v171, v171
    v_mfma_f32_16x16x32_bf16 v[36:39], a[60:63], v[188:191], v[36:39]
    v_exp_f32 v180, v180
    v_mfma_f32_16x16x32_bf16 v[172:175], a[0:3], v[132:135], v[204:207]
    v_exp_f32 v181, v181
    v_mfma_f32_16x16x32_bf16 v[172:175], a[4:7], v[136:139], v[172:175]
    v_exp_f32 v182, v182
    v_mfma_f32_16x16x32_bf16 v[172:175], a[8:11], v[140:143], v[172:175]
    v_exp_f32 v183, v183
    v_mfma_f32_16x16x32_bf16 v[172:175], a[12:15], v[144:147], v[172:175]
    v_exp_f32 v184, v184
    v_mfma_f32_16x16x32_bf16 v[176:179], a[16:19], v[132:135], v[204:207]
    v_exp_f32 v185, v185
    v_mfma_f32_16x16x32_bf16 v[176:179], a[20:23], v[136:139], v[176:179]
    v_exp_f32 v186, v186
    v_mfma_f32_16x16x32_bf16 v[176:179], a[24:27], v[140:143], v[176:179]
    v_exp_f32 v187, v187
    v_mfma_f32_16x16x32_bf16 v[176:179], a[28:31], v[144:147], v[176:179]
    v_cvt_pk_bf16_f32 v196, v180, v181
    v_cvt_pk_bf16_f32 v197, v182, v183
    v_mfma_f32_16x16x32_bf16 v[108:111], v[212:215], v[192:195], v[108:111]
    v_exp_f32 v172, v172
    v_mfma_f32_16x16x32_bf16 v[40:43], a[32:35], v[192:195], v[40:43]
    s_mov_b32 s76, 114688
    v_exp_f32 v173, v173
    v_mfma_f32_16x16x32_bf16 v[44:47], a[36:39], v[192:195], v[44:47]
    v_exp_f32 v174, v174
    v_mfma_f32_16x16x32_bf16 v[48:51], a[40:43], v[192:195], v[48:51]
    s_add_u32 m0, s72, 16384
    v_exp_f32 v175, v175
    v_mfma_f32_16x16x32_bf16 v[52:55], a[44:47], v[192:195], v[52:55]
    v_exp_f32 v176, v176
    v_mfma_f32_16x16x32_bf16 v[56:59], a[48:51], v[192:195], v[56:59]
    v_exp_f32 v177, v177
    v_mfma_f32_16x16x32_bf16 v[60:63], a[52:55], v[192:195], v[60:63]
    v_exp_f32 v178, v178
    v_mfma_f32_16x16x32_bf16 v[64:67], a[56:59], v[192:195], v[64:67]
    v_exp_f32 v179, v179
    v_mfma_f32_16x16x32_bf16 v[68:71], a[60:63], v[192:195], v[68:71]
    s_waitcnt vmcnt(14)
    s_barrier
    buffer_load_dwordx4 v228, s[32:35], s76 offen nt lds
    v_mfma_f32_16x16x32_bf16 v[180:183], a[0:3], v[148:151], v[208:211]
    s_add_u32 s78, s54, 65536
    ds_read_b128 a[0:3], v216 offset:32768
    v_cvt_pk_bf16_f32 v198, v184, v185
    v_mfma_f32_16x16x32_bf16 v[180:183], a[4:7], v[152:155], v[180:183]
    ds_read_b128 a[4:7], v217 offset:32768
    v_cvt_pk_bf16_f32 v199, v186, v187
    v_mfma_f32_16x16x32_bf16 v[180:183], a[8:11], v[156:159], v[180:183]
    ds_read_b128 a[8:11], v218 offset:32768
    v_cvt_pk_bf16_f32 v188, v164, v165
    v_mfma_f32_16x16x32_bf16 v[180:183], a[12:15], v[160:163], v[180:183]
    buffer_load_dwordx4 v229, s[32:35], s76 offen offset:1024 nt lds
    ds_read_b128 a[12:15], v219 offset:32768
    v_mfma_f32_16x16x32_bf16 v[184:187], a[16:19], v[148:151], v[208:211]
    s_add_u32 m0, s72, 24576
    ds_read_b128 a[16:19], v216 offset:36864
    v_cvt_pk_bf16_f32 v189, v166, v167
    v_mfma_f32_16x16x32_bf16 v[184:187], a[20:23], v[152:155], v[184:187]
    ds_read_b128 a[20:23], v217 offset:36864
    v_cvt_pk_bf16_f32 v190, v168, v169
    v_mfma_f32_16x16x32_bf16 v[184:187], a[24:27], v[156:159], v[184:187]
    ds_read_b128 a[24:27], v218 offset:36864
    v_cvt_pk_bf16_f32 v191, v170, v171
    v_mfma_f32_16x16x32_bf16 v[184:187], a[28:31], v[160:163], v[184:187]
    buffer_load_dwordx4 v244, s[40:43], s78 offen lds
    ds_read_b128 a[28:31], v219 offset:36864
    v_mfma_f32_16x16x32_bf16 v[112:115], v[212:215], v[196:199], v[112:115]
    s_mov_b32 s77, 106496
    v_mfma_f32_16x16x32_bf16 v[72:75], a[32:35], v[196:199], v[72:75]
    ds_read_b64_tr_b16 a[32:33], v220 offset:49152
    v_cvt_pk_bf16_f32 v192, v172, v173
    v_mfma_f32_16x16x32_bf16 v[76:79], a[36:39], v[196:199], v[76:79]
    ds_read_b64_tr_b16 a[34:35], v220 offset:53248
    v_cvt_pk_bf16_f32 v193, v174, v175
    v_mfma_f32_16x16x32_bf16 v[80:83], a[40:43], v[196:199], v[80:83]
    buffer_load_dwordx4 v245, s[40:43], s78 offen offset:1024 lds
    ds_read_b64_tr_b16 a[36:37], v221 offset:49152
    v_mfma_f32_16x16x32_bf16 v[84:87], a[44:47], v[196:199], v[84:87]
    s_add_u32 m0, s72, 155648
    ds_read_b64_tr_b16 a[38:39], v221 offset:53248
    v_cvt_pk_bf16_f32 v194, v176, v177
    v_mfma_f32_16x16x32_bf16 v[88:91], a[48:51], v[196:199], v[88:91]
    ds_read_b64_tr_b16 a[40:41], v222 offset:49152
    v_cvt_pk_bf16_f32 v195, v178, v179
    v_mfma_f32_16x16x32_bf16 v[92:95], a[52:55], v[196:199], v[92:95]
    ds_read_b64_tr_b16 a[42:43], v222 offset:53248
    v_mfma_f32_16x16x32_bf16 v[96:99], a[56:59], v[196:199], v[96:99]
    buffer_load_dwordx4 v230, s[36:39], s77 offen nt lds
    ds_read_b64_tr_b16 a[44:45], v223 offset:49152
    v_mfma_f32_16x16x32_bf16 v[100:103], a[60:63], v[196:199], v[100:103]
    ds_read_b64_tr_b16 a[46:47], v223 offset:53248
    s_waitcnt lgkmcnt(8)
    v_mfma_f32_16x16x32_bf16 v[164:167], a[0:3], v[116:119], v[200:203]
    ds_read_b64_tr_b16 a[48:49], v224 offset:49152
    v_mfma_f32_16x16x32_bf16 v[164:167], a[4:7], v[120:123], v[164:167]
    ds_read_b64_tr_b16 a[50:51], v224 offset:53248
    v_mfma_f32_16x16x32_bf16 v[164:167], a[8:11], v[124:127], v[164:167]
    buffer_load_dwordx4 v231, s[36:39], s77 offen offset:1024 nt lds
    ds_read_b64_tr_b16 a[52:53], v225 offset:49152
    v_mfma_f32_16x16x32_bf16 v[164:167], a[12:15], v[128:131], v[164:167]
    ds_read_b64_tr_b16 a[54:55], v225 offset:53248
    v_mfma_f32_16x16x32_bf16 v[168:171], a[16:19], v[116:119], v[200:203]
    ds_read_b64_tr_b16 a[56:57], v226 offset:49152
    v_mfma_f32_16x16x32_bf16 v[168:171], a[20:23], v[120:123], v[168:171]
    ds_read_b64_tr_b16 a[58:59], v226 offset:53248
    v_mfma_f32_16x16x32_bf16 v[168:171], a[24:27], v[124:127], v[168:171]
    ds_read_b64_tr_b16 a[60:61], v227 offset:49152
    v_mfma_f32_16x16x32_bf16 v[168:171], a[28:31], v[128:131], v[168:171]
    ds_read_b64_tr_b16 a[62:63], v227 offset:53248
    v_mfma_f32_16x16x32_bf16 v[104:107], v[212:215], v[188:191], v[104:107]
    s_waitcnt lgkmcnt(8)
    v_exp_f32 v164, v164
    v_mfma_f32_16x16x32_bf16 v[8:11], a[32:35], v[188:191], v[8:11]
    v_exp_f32 v165, v165
    v_mfma_f32_16x16x32_bf16 v[12:15], a[36:39], v[188:191], v[12:15]
    v_exp_f32 v166, v166
    v_mfma_f32_16x16x32_bf16 v[16:19], a[40:43], v[188:191], v[16:19]
    v_exp_f32 v167, v167
    v_mfma_f32_16x16x32_bf16 v[20:23], a[44:47], v[188:191], v[20:23]
    s_waitcnt lgkmcnt(4)
    v_exp_f32 v168, v168
    v_mfma_f32_16x16x32_bf16 v[24:27], a[48:51], v[188:191], v[24:27]
    v_exp_f32 v169, v169
    v_mfma_f32_16x16x32_bf16 v[28:31], a[52:55], v[188:191], v[28:31]
    s_waitcnt lgkmcnt(2)
    v_exp_f32 v170, v170
    v_mfma_f32_16x16x32_bf16 v[32:35], a[56:59], v[188:191], v[32:35]
    s_waitcnt lgkmcnt(0)
    v_exp_f32 v171, v171
    v_mfma_f32_16x16x32_bf16 v[36:39], a[60:63], v[188:191], v[36:39]
    v_exp_f32 v180, v180
    v_mfma_f32_16x16x32_bf16 v[172:175], a[0:3], v[132:135], v[204:207]
    v_exp_f32 v181, v181
    v_mfma_f32_16x16x32_bf16 v[172:175], a[4:7], v[136:139], v[172:175]
    v_exp_f32 v182, v182
    v_mfma_f32_16x16x32_bf16 v[172:175], a[8:11], v[140:143], v[172:175]
    v_exp_f32 v183, v183
    v_mfma_f32_16x16x32_bf16 v[172:175], a[12:15], v[144:147], v[172:175]
    v_exp_f32 v184, v184
    v_mfma_f32_16x16x32_bf16 v[176:179], a[16:19], v[132:135], v[204:207]
    v_exp_f32 v185, v185
    v_mfma_f32_16x16x32_bf16 v[176:179], a[20:23], v[136:139], v[176:179]
    v_exp_f32 v186, v186
    v_mfma_f32_16x16x32_bf16 v[176:179], a[24:27], v[140:143], v[176:179]
    v_exp_f32 v187, v187
    v_mfma_f32_16x16x32_bf16 v[176:179], a[28:31], v[144:147], v[176:179]
    v_cvt_pk_bf16_f32 v196, v180, v181
    v_cvt_pk_bf16_f32 v197, v182, v183
    v_mfma_f32_16x16x32_bf16 v[108:111], v[212:215], v[192:195], v[108:111]
    v_exp_f32 v172, v172
    v_mfma_f32_16x16x32_bf16 v[40:43], a[32:35], v[192:195], v[40:43]
    s_mov_b32 s76, 122880
    v_exp_f32 v173, v173
    v_mfma_f32_16x16x32_bf16 v[44:47], a[36:39], v[192:195], v[44:47]
    v_exp_f32 v174, v174
    v_mfma_f32_16x16x32_bf16 v[48:51], a[40:43], v[192:195], v[48:51]
    s_add_u32 m0, s72, 32768
    v_exp_f32 v175, v175
    v_mfma_f32_16x16x32_bf16 v[52:55], a[44:47], v[192:195], v[52:55]
    v_exp_f32 v176, v176
    v_mfma_f32_16x16x32_bf16 v[56:59], a[48:51], v[192:195], v[56:59]
    v_exp_f32 v177, v177
    v_mfma_f32_16x16x32_bf16 v[60:63], a[52:55], v[192:195], v[60:63]
    v_exp_f32 v178, v178
    v_mfma_f32_16x16x32_bf16 v[64:67], a[56:59], v[192:195], v[64:67]
    v_exp_f32 v179, v179
    v_mfma_f32_16x16x32_bf16 v[68:71], a[60:63], v[192:195], v[68:71]
    s_waitcnt vmcnt(14)
    s_barrier
    buffer_load_dwordx4 v228, s[32:35], s76 offen nt lds
    v_mfma_f32_16x16x32_bf16 v[180:183], a[0:3], v[148:151], v[208:211]
    s_add_u32 s78, s54, 98304
    ds_read_b128 a[0:3], v216 offset:0
    v_cvt_pk_bf16_f32 v198, v184, v185
    v_mfma_f32_16x16x32_bf16 v[180:183], a[4:7], v[152:155], v[180:183]
    ds_read_b128 a[4:7], v217 offset:0
    v_cvt_pk_bf16_f32 v199, v186, v187
    v_mfma_f32_16x16x32_bf16 v[180:183], a[8:11], v[156:159], v[180:183]
    ds_read_b128 a[8:11], v218 offset:0
    v_cvt_pk_bf16_f32 v188, v164, v165
    v_mfma_f32_16x16x32_bf16 v[180:183], a[12:15], v[160:163], v[180:183]
    buffer_load_dwordx4 v229, s[32:35], s76 offen offset:1024 nt lds
    ds_read_b128 a[12:15], v219 offset:0
    v_mfma_f32_16x16x32_bf16 v[184:187], a[16:19], v[148:151], v[208:211]
    s_add_u32 m0, s72, 122880
    ds_read_b128 a[16:19], v216 offset:4096
    v_cvt_pk_bf16_f32 v189, v166, v167
    v_mfma_f32_16x16x32_bf16 v[184:187], a[20:23], v[152:155], v[184:187]
    ds_read_b128 a[20:23], v217 offset:4096
    v_cvt_pk_bf16_f32 v190, v168, v169
    v_mfma_f32_16x16x32_bf16 v[184:187], a[24:27], v[156:159], v[184:187]
    ds_read_b128 a[24:27], v218 offset:4096
    v_cvt_pk_bf16_f32 v191, v170, v171
    v_mfma_f32_16x16x32_bf16 v[184:187], a[28:31], v[160:163], v[184:187]
    buffer_load_dwordx4 v244, s[40:43], s78 offen lds
    ds_read_b128 a[28:31], v219 offset:4096
    v_mfma_f32_16x16x32_bf16 v[112:115], v[212:215], v[196:199], v[112:115]
    v_mfma_f32_16x16x32_bf16 v[72:75], a[32:35], v[196:199], v[72:75]
    ds_read_b64_tr_b16 a[32:33], v220 offset:40960
    v_cvt_pk_bf16_f32 v192, v172, v173
    v_mfma_f32_16x16x32_bf16 v[76:79], a[36:39], v[196:199], v[76:79]
    ds_read_b64_tr_b16 a[34:35], v220 offset:45056
    v_cvt_pk_bf16_f32 v193, v174, v175
    v_mfma_f32_16x16x32_bf16 v[80:83], a[40:43], v[196:199], v[80:83]
    buffer_load_dwordx4 v245, s[40:43], s78 offen offset:1024 lds
    ds_read_b64_tr_b16 a[36:37], v221 offset:40960
    v_mfma_f32_16x16x32_bf16 v[84:87], a[44:47], v[196:199], v[84:87]
    ds_read_b64_tr_b16 a[38:39], v221 offset:45056
    v_cvt_pk_bf16_f32 v194, v176, v177
    v_mfma_f32_16x16x32_bf16 v[88:91], a[48:51], v[196:199], v[88:91]
    ds_read_b64_tr_b16 a[40:41], v222 offset:40960
    v_cvt_pk_bf16_f32 v195, v178, v179
    v_mfma_f32_16x16x32_bf16 v[92:95], a[52:55], v[196:199], v[92:95]
    ds_read_b64_tr_b16 a[42:43], v222 offset:45056
    v_mfma_f32_16x16x32_bf16 v[96:99], a[56:59], v[196:199], v[96:99]
    ds_read_b64_tr_b16 a[44:45], v223 offset:40960
    v_mfma_f32_16x16x32_bf16 v[100:103], a[60:63], v[196:199], v[100:103]
    s_mov_b32 s77, 114688
    ds_read_b64_tr_b16 a[46:47], v223 offset:45056
    s_waitcnt lgkmcnt(8)
    v_mfma_f32_16x16x32_bf16 v[164:167], a[0:3], v[116:119], v[200:203]
    ds_read_b64_tr_b16 a[48:49], v224 offset:40960
    v_mfma_f32_16x16x32_bf16 v[164:167], a[4:7], v[120:123], v[164:167]
    s_add_u32 m0, s72, 147456
    ds_read_b64_tr_b16 a[50:51], v224 offset:45056
    v_mfma_f32_16x16x32_bf16 v[164:167], a[8:11], v[124:127], v[164:167]
    ds_read_b64_tr_b16 a[52:53], v225 offset:40960
    v_mfma_f32_16x16x32_bf16 v[164:167], a[12:15], v[128:131], v[164:167]
    ds_read_b64_tr_b16 a[54:55], v225 offset:45056
    v_mfma_f32_16x16x32_bf16 v[168:171], a[16:19], v[116:119], v[200:203]
    ds_read_b64_tr_b16 a[56:57], v226 offset:40960
    v_mfma_f32_16x16x32_bf16 v[168:171], a[20:23], v[120:123], v[168:171]
    ds_read_b64_tr_b16 a[58:59], v226 offset:45056
    v_mfma_f32_16x16x32_bf16 v[168:171], a[24:27], v[124:127], v[168:171]
    ds_read_b64_tr_b16 a[60:61], v227 offset:40960
    buffer_load_dwordx4 v230, s[36:39], s77 offen nt lds
    v_mfma_f32_16x16x32_bf16 v[168:171], a[28:31], v[128:131], v[168:171]
    ds_read_b64_tr_b16 a[62:63], v227 offset:45056
    v_mfma_f32_16x16x32_bf16 v[104:107], v[212:215], v[188:191], v[104:107]
    s_waitcnt lgkmcnt(8)
    v_exp_f32 v164, v164
    v_mfma_f32_16x16x32_bf16 v[8:11], a[32:35], v[188:191], v[8:11]
    v_exp_f32 v165, v165
    v_mfma_f32_16x16x32_bf16 v[12:15], a[36:39], v[188:191], v[12:15]
    v_exp_f32 v166, v166
    v_mfma_f32_16x16x32_bf16 v[16:19], a[40:43], v[188:191], v[16:19]
    v_exp_f32 v167, v167
    v_mfma_f32_16x16x32_bf16 v[20:23], a[44:47], v[188:191], v[20:23]
    s_waitcnt lgkmcnt(4)
    buffer_load_dwordx4 v231, s[36:39], s77 offen offset:1024 nt lds
    v_exp_f32 v168, v168
    v_mfma_f32_16x16x32_bf16 v[24:27], a[48:51], v[188:191], v[24:27]
    v_exp_f32 v169, v169
    v_mfma_f32_16x16x32_bf16 v[28:31], a[52:55], v[188:191], v[28:31]
    s_waitcnt lgkmcnt(2)
    v_exp_f32 v170, v170
    v_mfma_f32_16x16x32_bf16 v[32:35], a[56:59], v[188:191], v[32:35]
    s_waitcnt lgkmcnt(0)
    v_exp_f32 v171, v171
    v_mfma_f32_16x16x32_bf16 v[36:39], a[60:63], v[188:191], v[36:39]
    v_exp_f32 v180, v180
    v_mfma_f32_16x16x32_bf16 v[172:175], a[0:3], v[132:135], v[204:207]
    v_exp_f32 v181, v181
    v_mfma_f32_16x16x32_bf16 v[172:175], a[4:7], v[136:139], v[172:175]
    v_exp_f32 v182, v182
    v_mfma_f32_16x16x32_bf16 v[172:175], a[8:11], v[140:143], v[172:175]
    v_exp_f32 v183, v183
    v_mfma_f32_16x16x32_bf16 v[172:175], a[12:15], v[144:147], v[172:175]
    v_exp_f32 v184, v184
    v_mfma_f32_16x16x32_bf16 v[176:179], a[16:19], v[132:135], v[204:207]
    v_exp_f32 v185, v185
    v_mfma_f32_16x16x32_bf16 v[176:179], a[20:23], v[136:139], v[176:179]
    v_exp_f32 v186, v186
    v_mfma_f32_16x16x32_bf16 v[176:179], a[24:27], v[140:143], v[176:179]
    v_exp_f32 v187, v187
    v_mfma_f32_16x16x32_bf16 v[176:179], a[28:31], v[144:147], v[176:179]
    v_cvt_pk_bf16_f32 v196, v180, v181
    v_cvt_pk_bf16_f32 v197, v182, v183
    v_mfma_f32_16x16x32_bf16 v[108:111], v[212:215], v[192:195], v[108:111]
    v_exp_f32 v172, v172
    v_mfma_f32_16x16x32_bf16 v[40:43], a[32:35], v[192:195], v[40:43]
    s_mov_b32 s77, 122880
    v_exp_f32 v173, v173
    v_mfma_f32_16x16x32_bf16 v[44:47], a[36:39], v[192:195], v[44:47]
    v_exp_f32 v174, v174
    v_mfma_f32_16x16x32_bf16 v[48:51], a[40:43], v[192:195], v[48:51]
    s_add_u32 m0, s72, 139264
    v_exp_f32 v175, v175
    v_mfma_f32_16x16x32_bf16 v[52:55], a[44:47], v[192:195], v[52:55]
    v_exp_f32 v176, v176
    v_mfma_f32_16x16x32_bf16 v[56:59], a[48:51], v[192:195], v[56:59]
    v_exp_f32 v177, v177
    v_mfma_f32_16x16x32_bf16 v[60:63], a[52:55], v[192:195], v[60:63]
    v_exp_f32 v178, v178
    v_mfma_f32_16x16x32_bf16 v[64:67], a[56:59], v[192:195], v[64:67]
    v_exp_f32 v179, v179
    v_mfma_f32_16x16x32_bf16 v[68:71], a[60:63], v[192:195], v[68:71]
    s_waitcnt vmcnt(12)
    s_barrier
    buffer_load_dwordx4 v230, s[36:39], s77 offen nt lds
    v_mfma_f32_16x16x32_bf16 v[180:183], a[0:3], v[148:151], v[208:211]
    s_add_u32 s78, s55, 0
    ds_read_b128 a[0:3], v216 offset:8192
    v_cvt_pk_bf16_f32 v198, v184, v185
    v_mfma_f32_16x16x32_bf16 v[180:183], a[4:7], v[152:155], v[180:183]
    ds_read_b128 a[4:7], v217 offset:8192
    v_cvt_pk_bf16_f32 v199, v186, v187
    v_mfma_f32_16x16x32_bf16 v[180:183], a[8:11], v[156:159], v[180:183]
L_pg5:
    s_cbranch_execz L_warmed
    ds_read_b128 a[8:11], v218 offset:8192
    v_cvt_pk_bf16_f32 v188, v164, v165
    v_mfma_f32_16x16x32_bf16 v[180:183], a[12:15], v[160:163], v[180:183]
    buffer_load_dwordx4 v231, s[36:39], s77 offen offset:1024 nt lds
    ds_read_b128 a[12:15], v219 offset:8192
    v_mfma_f32_16x16x32_bf16 v[184:187], a[16:19], v[148:151], v[208:211]
    s_add_u32 m0, s72, 0
    ds_read_b128 a[16:19], v216 offset:12288
    v_cvt_pk_bf16_f32 v189, v166, v167
    v_mfma_f32_16x16x32_bf16 v[184:187], a[20:23], v[152:155], v[184:187]
    s_add_u32 s79, s88, 2097152
    ds_read_b128 a[20:23], v217 offset:12288
    v_cvt_pk_bf16_f32 v190, v168, v169
    v_mfma_f32_16x16x32_bf16 v[184:187], a[24:27], v[156:159], v[184:187]
    ds_read_b128 a[24:27], v218 offset:12288
    v_cvt_pk_bf16_f32 v191, v170, v171
    v_mfma_f32_16x16x32_bf16 v[184:187], a[28:31], v[160:163], v[184:187]
    buffer_load_dwordx4 v244, s[40:43], s78 offen lds
    ds_read_b128 a[28:31], v219 offset:12288
    v_mfma_f32_16x16x32_bf16 v[112:115], v[212:215], v[196:199], v[112:115]
    v_mfma_f32_16x16x32_bf16 v[72:75], a[32:35], v[196:199], v[72:75]
    ds_read_b64_tr_b16 a[32:33], v220 offset:32768
    v_cvt_pk_bf16_f32 v192, v172, v173
    v_mfma_f32_16x16x32_bf16 v[76:79], a[36:39], v[196:199], v[76:79]
    ds_read_b64_tr_b16 a[34:35], v220 offset:36864
    v_cvt_pk_bf16_f32 v193, v174, v175
    v_mfma_f32_16x16x32_bf16 v[80:83], a[40:43], v[196:199], v[80:83]
    buffer_load_dwordx4 v245, s[40:43], s78 offen offset:1024 lds
    buffer_load_dword v247, v242, s[44:47], s79 offen sc1
    ds_read_b64_tr_b16 a[36:37], v221 offset:32768
    v_mfma_f32_16x16x32_bf16 v[84:87], a[44:47], v[196:199], v[84:87]
    s_add_u32 s79, s86, 0
    ds_read_b64_tr_b16 a[38:39], v221 offset:36864
    v_cvt_pk_bf16_f32 v194, v176, v177
    v_mfma_f32_16x16x32_bf16 v[88:91], a[48:51], v[196:199], v[88:91]
    ds_read_b64_tr_b16 a[40:41], v222 offset:32768
    v_cvt_pk_bf16_f32 v195, v178, v179
    v_mfma_f32_16x16x32_bf16 v[92:95], a[52:55], v[196:199], v[92:95]
    ds_read_b64_tr_b16 a[42:43], v222 offset:36864
    v_mfma_f32_16x16x32_bf16 v[96:99], a[56:59], v[196:199], v[96:99]
    ds_read_b64_tr_b16 a[44:45], v223 offset:32768
    v_mfma_f32_16x16x32_bf16 v[100:103], a[60:63], v[196:199], v[100:103]
    ds_read_b64_tr_b16 a[46:47], v223 offset:36864
    s_waitcnt lgkmcnt(8)
    v_mfma_f32_16x16x32_bf16 v[164:167], a[0:3], v[116:119], v[200:203]
    ds_read_b64_tr_b16 a[48:49], v224 offset:32768
    v_mfma_f32_16x16x32_bf16 v[164:167], a[4:7], v[120:123], v[164:167]
    ds_read_b64_tr_b16 a[50:51], v224 offset:36864
    v_mfma_f32_16x16x32_bf16 v[164:167], a[8:11], v[124:127], v[164:167]
    ds_read_b64_tr_b16 a[52:53], v225 offset:32768
    v_mfma_f32_16x16x32_bf16 v[164:167], a[12:15], v[128:131], v[164:167]
    ds_read_b64_tr_b16 a[54:55], v225 offset:36864
    v_mfma_f32_16x16x32_bf16 v[168:171], a[16:19], v[116:119], v[200:203]
    ds_read_b64_tr_b16 a[56:57], v226 offset:32768
    v_mfma_f32_16x16x32_bf16 v[168:171], a[20:23], v[120:123], v[168:171]
    ds_read_b64_tr_b16 a[58:59], v226 offset:36864
    v_mfma_f32_16x16x32_bf16 v[168:171], a[24:27], v[124:127], v[168:171]
    ds_read_b64_tr_b16 a[60:61], v227 offset:32768
    v_mfma_f32_16x16x32_bf16 v[168:171], a[28:31], v[128:131], v[168:171]
    ds_read_b64_tr_b16 a[62:63], v227 offset:36864
    v_mfma_f32_16x16x32_bf16 v[104:107], v[212:215], v[188:191], v[104:107]
    s_waitcnt lgkmcnt(8)
    v_exp_f32 v164, v164
    v_mfma_f32_16x16x32_bf16 v[8:11], a[32:35], v[188:191], v[8:11]
    v_exp_f32 v165, v165
    v_mfma_f32_16x16x32_bf16 v[12:15], a[36:39], v[188:191], v[12:15]
    v_exp_f32 v166, v166
    v_mfma_f32_16x16x32_bf16 v[16:19], a[40:43], v[188:191], v[16:19]
    v_exp_f32 v167, v167
    v_mfma_f32_16x16x32_bf16 v[20:23], a[44:47], v[188:191], v[20:23]
    s_waitcnt lgkmcnt(4)
    v_exp_f32 v168, v168
    v_mfma_f32_16x16x32_bf16 v[24:27], a[48:51], v[188:191], v[24:27]
    v_exp_f32 v169, v169
    v_mfma_f32_16x16x32_bf16 v[28:31], a[52:55], v[188:191], v[28:31]
    s_waitcnt lgkmcnt(2)
    v_exp_f32 v170, v170
    v_mfma_f32_16x16x32_bf16 v[32:35], a[56:59], v[188:191], v[32:35]
    s_waitcnt lgkmcnt(0)
    v_exp_f32 v171, v171
    v_mfma_f32_16x16x32_bf16 v[36:39], a[60:63], v[188:191], v[36:39]
    v_exp_f32 v180, v180
    v_mfma_f32_16x16x32_bf16 v[172:175], a[0:3], v[132:135], v[204:207]
    v_exp_f32 v181, v181
    v_mfma_f32_16x16x32_bf16 v[172:175], a[4:7], v[136:139], v[172:175]
    v_exp_f32 v182, v182
    v_mfma_f32_16x16x32_bf16 v[172:175], a[8:11], v[140:143], v[172:175]
    v_exp_f32 v183, v183
    v_mfma_f32_16x16x32_bf16 v[172:175], a[12:15], v[144:147], v[172:175]
    v_exp_f32 v184, v184
    v_mfma_f32_16x16x32_bf16 v[176:179], a[16:19], v[132:135], v[204:207]
    v_exp_f32 v185, v185
    v_mfma_f32_16x16x32_bf16 v[176:179], a[20:23], v[136:139], v[176:179]
    v_exp_f32 v186, v186
    v_mfma_f32_16x16x32_bf16 v[176:179], a[24:27], v[140:143], v[176:179]
    v_exp_f32 v187, v187
    v_mfma_f32_16x16x32_bf16 v[176:179], a[28:31], v[144:147], v[176:179]
    v_cvt_pk_bf16_f32 v196, v180, v181
    v_cvt_pk_bf16_f32 v197, v182, v183
    v_mfma_f32_16x16x32_bf16 v[108:111], v[212:215], v[192:195], v[108:111]
    v_exp_f32 v172, v172
    v_mfma_f32_16x16x32_bf16 v[40:43], a[32:35], v[192:195], v[40:43]
    s_add_u32 s78, s55, 32768
    v_exp_f32 v173, v173
    v_mfma_f32_16x16x32_bf16 v[44:47], a[36:39], v[192:195], v[44:47]
    v_exp_f32 v174, v174
    v_mfma_f32_16x16x32_bf16 v[48:51], a[40:43], v[192:195], v[48:51]
    s_add_u32 m0, s72, 131072
    v_exp_f32 v175, v175
    v_mfma_f32_16x16x32_bf16 v[52:55], a[44:47], v[192:195], v[52:55]
    v_exp_f32 v176, v176
    v_mfma_f32_16x16x32_bf16 v[56:59], a[48:51], v[192:195], v[56:59]
    v_exp_f32 v177, v177
    v_mfma_f32_16x16x32_bf16 v[60:63], a[52:55], v[192:195], v[60:63]
    v_exp_f32 v178, v178
    v_mfma_f32_16x16x32_bf16 v[64:67], a[56:59], v[192:195], v[64:67]
    v_exp_f32 v179, v179
    v_mfma_f32_16x16x32_bf16 v[68:71], a[60:63], v[192:195], v[68:71]
    s_waitcnt vmcnt(11)
    s_barrier
    buffer_load_dwordx4 v244, s[40:43], s78 offen lds
    v_mfma_f32_16x16x32_bf16 v[180:183], a[0:3], v[148:151], v[208:211]
    ds_read_b128 a[0:3], v216 offset:16384
    v_cvt_pk_bf16_f32 v198, v184, v185
    v_mfma_f32_16x16x32_bf16 v[180:183], a[4:7], v[152:155], v[180:183]
    ds_read_b128 a[4:7], v217 offset:16384
    v_cvt_pk_bf16_f32 v199, v186, v187
    v_mfma_f32_16x16x32_bf16 v[180:183], a[8:11], v[156:159], v[180:183]
    ds_read_b128 a[8:11], v218 offset:16384
    v_cvt_pk_bf16_f32 v188, v164, v165
    v_mfma_f32_16x16x32_bf16 v[180:183], a[12:15], v[160:163], v[180:183]
    buffer_load_dwordx4 v245, s[40:43], s78 offen offset:1024 lds
    ds_read_b128 a[12:15], v219 offset:16384
    v_mfma_f32_16x16x32_bf16 v[184:187], a[16:19], v[148:151], v[208:211]
    ds_read_b128 a[16:19], v216 offset:20480
    v_cvt_pk_bf16_f32 v189, v166, v167
    v_mfma_f32_16x16x32_bf16 v[184:187], a[20:23], v[152:155], v[184:187]
    ds_read_b128 a[20:23], v217 offset:20480
    v_cvt_pk_bf16_f32 v190, v168, v169
    v_mfma_f32_16x16x32_bf16 v[184:187], a[24:27], v[156:159], v[184:187]
    ds_read_b128 a[24:27], v218 offset:20480
    v_cvt_pk_bf16_f32 v191, v170, v171
    v_mfma_f32_16x16x32_bf16 v[184:187], a[28:31], v[160:163], v[184:187]
    ds_read_b128 a[28:31], v219 offset:20480
    v_mfma_f32_16x16x32_bf16 v[112:115], v[212:215], v[196:199], v[112:115]
    v_mfma_f32_16x16x32_bf16 v[72:75], a[32:35], v[196:199], v[72:75]
    ds_read_b64_tr_b16 a[32:33], v220 offset:57344
    v_cvt_pk_bf16_f32 v192, v172, v173
    v_mfma_f32_16x16x32_bf16 v[76:79], a[36:39], v[196:199], v[76:79]
    ds_read_b64_tr_b16 a[34:35], v220 offset:61440
    v_cvt_pk_bf16_f32 v193, v174, v175
    v_mfma_f32_16x16x32_bf16 v[80:83], a[40:43], v[196:199], v[80:83]
    ds_read_b64_tr_b16 a[36:37], v221 offset:57344
    v_mfma_f32_16x16x32_bf16 v[84:87], a[44:47], v[196:199], v[84:87]
    ds_read_b64_tr_b16 a[38:39], v221 offset:61440
    v_cvt_pk_bf16_f32 v194, v176, v177
    v_mfma_f32_16x16x32_bf16 v[88:91], a[48:51], v[196:199], v[88:91]
    ds_read_b64_tr_b16 a[40:41], v222 offset:57344
    v_cvt_pk_bf16_f32 v195, v178, v179
    v_mfma_f32_16x16x32_bf16 v[92:95], a[52:55], v[196:199], v[92:95]
    ds_read_b64_tr_b16 a[42:43], v222 offset:61440
    v_mfma_f32_16x16x32_bf16 v[96:99], a[56:59], v[196:199], v[96:99]
    ds_read_b64_tr_b16 a[44:45], v223 offset:57344
    v_mfma_f32_16x16x32_bf16 v[100:103], a[60:63], v[196:199], v[100:103]
    ds_read_b64_tr_b16 a[46:47], v223 offset:61440
    s_waitcnt lgkmcnt(8)
    v_mfma_f32_16x16x32_bf16 v[164:167], a[0:3], v[116:119], v[200:203]
    ds_read_b64_tr_b16 a[48:49], v224 offset:57344
    v_mfma_f32_16x16x32_bf16 v[164:167], a[4:7], v[120:123], v[164:167]
    ds_read_b64_tr_b16 a[50:51], v224 offset:61440
    v_mfma_f32_16x16x32_bf16 v[164:167], a[8:11], v[124:127], v[164:167]
    ds_read_b64_tr_b16 a[52:53], v225 offset:57344
    v_mfma_f32_16x16x32_bf16 v[164:167], a[12:15], v[128:131], v[164:167]
    ds_read_b64_tr_b16 a[54:55], v225 offset:61440
    v_mfma_f32_16x16x32_bf16 v[168:171], a[16:19], v[116:119], v[200:203]
    ds_read_b64_tr_b16 a[56:57], v226 offset:57344
    v_mfma_f32_16x16x32_bf16 v[168:171], a[20:23], v[120:123], v[168:171]
    ds_read_b64_tr_b16 a[58:59], v226 offset:61440
    v_mfma_f32_16x16x32_bf16 v[168:171], a[24:27], v[124:127], v[168:171]
    ds_read_b64_tr_b16 a[60:61], v227 offset:57344
    v_mfma_f32_16x16x32_bf16 v[168:171], a[28:31], v[128:131], v[168:171]
    ds_read_b64_tr_b16 a[62:63], v227 offset:61440
    v_mfma_f32_16x16x32_bf16 v[104:107], v[212:215], v[188:191], v[104:107]
    s_waitcnt lgkmcnt(8)
    v_exp_f32 v164, v164
    v_mfma_f32_16x16x32_bf16 v[8:11], a[32:35], v[188:191], v[8:11]
    v_exp_f32 v165, v165
    v_mfma_f32_16x16x32_bf16 v[12:15], a[36:39], v[188:191], v[12:15]
    v_exp_f32 v166, v166
    v_mfma_f32_16x16x32_bf16 v[16:19], a[40:43], v[188:191], v[16:19]
    v_exp_f32 v167, v167
    v_mfma_f32_16x16x32_bf16 v[20:23], a[44:47], v[188:191], v[20:23]
    s_waitcnt lgkmcnt(4)
    v_exp_f32 v168, v168
    v_mfma_f32_16x16x32_bf16 v[24:27], a[48:51], v[188:191], v[24:27]
    v_exp_f32 v169, v169
    v_mfma_f32_16x16x32_bf16 v[28:31], a[52:55], v[188:191], v[28:31]
    s_waitcnt lgkmcnt(2)
    v_exp_f32 v170, v170
    v_mfma_f32_16x16x32_bf16 v[32:35], a[56:59], v[188:191], v[32:35]
    s_waitcnt lgkmcnt(0)
    v_exp_f32 v171, v171
    v_mfma_f32_16x16x32_bf16 v[36:39], a[60:63], v[188:191], v[36:39]
    v_exp_f32 v180, v180
    v_mfma_f32_16x16x32_bf16 v[172:175], a[0:3], v[132:135], v[204:207]
    v_exp_f32 v181, v181
    v_mfma_f32_16x16x32_bf16 v[172:175], a[4:7], v[136:139], v[172:175]
    v_exp_f32 v182, v182
    v_mfma_f32_16x16x32_bf16 v[172:175], a[8:11], v[140:143], v[172:175]
    v_exp_f32 v183, v183
    v_mfma_f32_16x16x32_bf16 v[172:175], a[12:15], v[144:147], v[172:175]
    v_exp_f32 v184, v184
    v_mfma_f32_16x16x32_bf16 v[176:179], a[16:19], v[132:135], v[204:207]
    v_exp_f32 v185, v185
    v_mfma_f32_16x16x32_bf16 v[176:179], a[20:23], v[136:139], v[176:179]
    v_exp_f32 v186, v186
    v_mfma_f32_16x16x32_bf16 v[176:179], a[24:27], v[140:143], v[176:179]
    v_exp_f32 v187, v187
    v_mfma_f32_16x16x32_bf16 v[176:179], a[28:31], v[144:147], v[176:179]
    v_cvt_pk_bf16_f32 v196, v180, v181
    v_cvt_pk_bf16_f32 v197, v182, v183
    v_mfma_f32_16x16x32_bf16 v[108:111], v[212:215], v[192:195], v[108:111]
    v_exp_f32 v172, v172
    v_mfma_f32_16x16x32_bf16 v[40:43], a[32:35], v[192:195], v[40:43]
    s_add_u32 s78, s55, 65536
    v_exp_f32 v173, v173
    v_mfma_f32_16x16x32_bf16 v[44:47], a[36:39], v[192:195], v[44:47]
    v_exp_f32 v174, v174
    v_mfma_f32_16x16x32_bf16 v[48:51], a[40:43], v[192:195], v[48:51]
    s_add_u32 m0, s72, 16384
    v_exp_f32 v175, v175
    v_mfma_f32_16x16x32_bf16 v[52:55], a[44:47], v[192:195], v[52:55]
    v_exp_f32 v176, v176
    v_mfma_f32_16x16x32_bf16 v[56:59], a[48:51], v[192:195], v[56:59]
    v_exp_f32 v177, v177
    v_mfma_f32_16x16x32_bf16 v[60:63], a[52:55], v[192:195], v[60:63]
    v_exp_f32 v178, v178
    v_mfma_f32_16x16x32_bf16 v[64:67], a[56:59], v[192:195], v[64:67]
    v_exp_f32 v179, v179
    v_mfma_f32_16x16x32_bf16 v[68:71], a[60:63], v[192:195], v[68:71]
    s_waitcnt vmcnt(7)
    s_barrier
    buffer_load_dwordx4 v244, s[40:43], s78 offen lds
    v_mfma_f32_16x16x32_bf16 v[180:183], a[0:3], v[148:151], v[208:211]
    ds_read_b128 a[0:3], v216 offset:32768
    v_cvt_pk_bf16_f32 v198, v184, v185
    v_mfma_f32_16x16x32_bf16 v[180:183], a[4:7], v[152:155], v[180:183]
    ds_read_b128 a[4:7], v217 offset:32768
    v_cvt_pk_bf16_f32 v199, v186, v187
    v_mfma_f32_16x16x32_bf16 v[180:183], a[8:11], v[156:159], v[180:183]
    ds_read_b128 a[8:11], v218 offset:32768
    v_cvt_pk_bf16_f32 v188, v164, v165
    v_mfma_f32_16x16x32_bf16 v[180:183], a[12:15], v[160:163], v[180:183]
    buffer_load_dwordx4 v245, s[40:43], s78 offen offset:1024 lds
    ds_read_b128 a[12:15], v219 offset:32768
    v_mfma_f32_16x16x32_bf16 v[184:187], a[16:19], v[148:151], v[208:211]
    ds_read_b128 a[16:19], v216 offset:36864
    v_cvt_pk_bf16_f32 v189, v166, v167
    v_mfma_f32_16x16x32_bf16 v[184:187], a[20:23], v[152:155], v[184:187]
    ds_read_b128 a[20:23], v217 offset:36864
    v_cvt_pk_bf16_f32 v190, v168, v169
    v_mfma_f32_16x16x32_bf16 v[184:187], a[24:27], v[156:159], v[184:187]
    ds_read_b128 a[24:27], v218 offset:36864
    v_cvt_pk_bf16_f32 v191, v170, v171
    v_mfma_f32_16x16x32_bf16 v[184:187], a[28:31], v[160:163], v[184:187]
    ds_read_b128 a[28:31], v219 offset:36864
    v_mfma_f32_16x16x32_bf16 v[112:115], v[212:215], v[196:199], v[112:115]
    v_exp_f32 v180, v180
    v_mfma_f32_16x16x32_bf16 v[72:75], a[32:35], v[196:199], v[72:75]
    ds_read_b64_tr_b16 a[32:33], v220 offset:49152
    v_cvt_pk_bf16_f32 v192, v172, v173
    v_mfma_f32_16x16x32_bf16 v[76:79], a[36:39], v[196:199], v[76:79]
    ds_read_b64_tr_b16 a[34:35], v220 offset:53248
    v_cvt_pk_bf16_f32 v193, v174, v175
    v_mfma_f32_16x16x32_bf16 v[80:83], a[40:43], v[196:199], v[80:83]
    ds_read_b64_tr_b16 a[36:37], v221 offset:49152
    v_mfma_f32_16x16x32_bf16 v[84:87], a[44:47], v[196:199], v[84:87]
    ds_read_b64_tr_b16 a[38:39], v221 offset:53248
    v_cvt_pk_bf16_f32 v194, v176, v177
    v_mfma_f32_16x16x32_bf16 v[88:91], a[48:51], v[196:199], v[88:91]
    ds_read_b64_tr_b16 a[40:41], v222 offset:49152
    v_cvt_pk_bf16_f32 v195, v178, v179
    v_mfma_f32_16x16x32_bf16 v[92:95], a[52:55], v[196:199], v[92:95]
    ds_read_b64_tr_b16 a[42:43], v222 offset:53248
    v_mfma_f32_16x16x32_bf16 v[96:99], a[56:59], v[196:199], v[96:99]
    ds_read_b64_tr_b16 a[44:45], v223 offset:49152
    v_mfma_f32_16x16x32_bf16 v[100:103], a[60:63], v[196:199], v[100:103]
    ds_read_b64_tr_b16 a[46:47], v223 offset:53248
    s_waitcnt lgkmcnt(8)
    v_mfma_f32_16x16x32_bf16 v[164:167], a[0:3], v[116:119], v[200:203]
    ds_read_b64_tr_b16 a[48:49], v224 offset:49152
    v_mfma_f32_16x16x32_bf16 v[164:167], a[4:7], v[120:123], v[164:167]
    ds_read_b64_tr_b16 a[50:51], v224 offset:53248
    v_mfma_f32_16x16x32_bf16 v[164:167], a[8:11], v[124:127], v[164:167]
    ds_read_b64_tr_b16 a[52:53], v225 offset:49152
    v_mfma_f32_16x16x32_bf16 v[164:167], a[12:15], v[128:131], v[164:167]
    ds_read_b64_tr_b16 a[54:55], v225 offset:53248
    v_mfma_f32_16x16x32_bf16 v[168:171], a[16:19], v[116:119], v[200:203]
    ds_read_b64_tr_b16 a[56:57], v226 offset:49152
    v_mfma_f32_16x16x32_bf16 v[168:171], a[20:23], v[120:123], v[168:171]
    ds_read_b64_tr_b16 a[58:59], v226 offset:53248
    v_mfma_f32_16x16x32_bf16 v[168:171], a[24:27], v[124:127], v[168:171]
    ds_read_b64_tr_b16 a[60:61], v227 offset:49152
    v_mfma_f32_16x16x32_bf16 v[168:171], a[28:31], v[128:131], v[168:171]
    s_waitcnt vmcnt(7)
    s_barrier
    ds_read_b64_tr_b16 a[62:63], v227 offset:53248
    v_mfma_f32_16x16x32_bf16 v[104:107], v[212:215], v[188:191], v[104:107]
    s_waitcnt lgkmcnt(8)
    v_exp_f32 v164, v164
    v_mfma_f32_16x16x32_bf16 v[8:11], a[32:35], v[188:191], v[8:11]
    v_exp_f32 v165, v165
    v_mfma_f32_16x16x32_bf16 v[12:15], a[36:39], v[188:191], v[12:15]
    v_exp_f32 v166, v166
    v_mfma_f32_16x16x32_bf16 v[16:19], a[40:43], v[188:191], v[16:19]
    v_exp_f32 v167, v167
    v_mfma_f32_16x16x32_bf16 v[20:23], a[44:47], v[188:191], v[20:23]
    s_waitcnt lgkmcnt(4)
    v_exp_f32 v168, v168
    v_mfma_f32_16x16x32_bf16 v[24:27], a[48:51], v[188:191], v[24:27]
    v_exp_f32 v169, v169
    v_mfma_f32_16x16x32_bf16 v[28:31], a[52:55], v[188:191], v[28:31]
    s_waitcnt lgkmcnt(2)
    v_exp_f32 v170, v170
    v_mfma_f32_16x16x32_bf16 v[32:35], a[56:59], v[188:191], v[32:35]
    s_waitcnt lgkmcnt(0)
    v_exp_f32 v171, v171
    v_mfma_f32_16x16x32_bf16 v[36:39], a[60:63], v[188:191], v[36:39]
    ds_read_b64_tr_b16 a[64:65], v220 offset:40960
    ds_read_b64_tr_b16 a[66:67], v220 offset:45056
    v_mfma_f32_16x16x32_bf16 v[172:175], a[0:3], v[132:135], v[204:207]
    ds_read_b64_tr_b16 a[68:69], v221 offset:40960
    v_cvt_pk_bf16_f32 v188, v164, v165
    v_mfma_f32_16x16x32_bf16 v[172:175], a[4:7], v[136:139], v[172:175]
    ds_read_b64_tr_b16 a[70:71], v221 offset:45056
    v_cvt_pk_bf16_f32 v189, v166, v167
    v_mfma_f32_16x16x32_bf16 v[172:175], a[8:11], v[140:143], v[172:175]
    ds_read_b64_tr_b16 a[72:73], v222 offset:40960
    v_cvt_pk_bf16_f32 v190, v168, v169
    v_mfma_f32_16x16x32_bf16 v[172:175], a[12:15], v[144:147], v[172:175]
    ds_read_b64_tr_b16 a[74:75], v222 offset:45056
    v_cvt_pk_bf16_f32 v191, v170, v171
    v_mfma_f32_16x16x32_bf16 v[176:179], a[16:19], v[132:135], v[204:207]
    ds_read_b64_tr_b16 a[76:77], v223 offset:40960
    ds_read_b64_tr_b16 a[78:79], v223 offset:45056
    v_mfma_f32_16x16x32_bf16 v[176:179], a[20:23], v[136:139], v[176:179]
    ds_read_b64_tr_b16 a[80:81], v224 offset:40960
    ds_read_b64_tr_b16 a[82:83], v224 offset:45056
    v_mfma_f32_16x16x32_bf16 v[176:179], a[24:27], v[140:143], v[176:179]
    ds_read_b64_tr_b16 a[84:85], v225 offset:40960
    ds_read_b64_tr_b16 a[86:87], v225 offset:45056
    v_mfma_f32_16x16x32_bf16 v[176:179], a[28:31], v[144:147], v[176:179]
    ds_read_b64_tr_b16 a[88:89], v226 offset:40960
    ds_read_b64_tr_b16 a[90:91], v226 offset:45056
    v_mfma_f32_16x16x32_bf16 v[104:107], v[212:215], v[188:191], v[104:107]
    s_waitcnt lgkmcnt(12)
    ds_read_b64_tr_b16 a[92:93], v227 offset:40960
    ds_read_b64_tr_b16 a[94:95], v227 offset:45056
    v_mfma_f32_16x16x32_bf16 v[8:11], a[64:67], v[188:191], v[8:11]
    s_waitcnt lgkmcnt(12)
    s_add_u32 s78, s55, 98304
    v_exp_f32 v181, v181
    v_mfma_f32_16x16x32_bf16 v[12:15], a[68:71], v[188:191], v[12:15]
    s_waitcnt lgkmcnt(10)
    v_exp_f32 v182, v182
    v_mfma_f32_16x16x32_bf16 v[16:19], a[72:75], v[188:191], v[16:19]
    s_waitcnt lgkmcnt(8)
    s_add_u32 m0, s72, 32768
    v_exp_f32 v183, v183
    v_mfma_f32_16x16x32_bf16 v[20:23], a[76:79], v[188:191], v[20:23]
    s_waitcnt lgkmcnt(6)
    v_rcp_f32 v105, v104
    v_mfma_f32_16x16x32_bf16 v[24:27], a[80:83], v[188:191], v[24:27]
    s_waitcnt lgkmcnt(4)
    v_mul_f32 v8, v105, v8
    v_mul_f32 v9, v105, v9
    v_mfma_f32_16x16x32_bf16 v[28:31], a[84:87], v[188:191], v[28:31]
    s_waitcnt lgkmcnt(2)
    v_mul_f32 v10, v105, v10
    v_mul_f32 v11, v105, v11
    v_mfma_f32_16x16x32_bf16 v[32:35], a[88:91], v[188:191], v[32:35]
    s_waitcnt lgkmcnt(0)
    v_cvt_pk_bf16_f32 v164, v8, v9
    v_cvt_pk_bf16_f32 v165, v10, v11
    v_mfma_f32_16x16x32_bf16 v[36:39], a[92:95], v[188:191], v[36:39]
    buffer_load_dwordx4 v244, s[40:43], s78 offen lds
    v_mul_f32 v12, v105, v12
    v_mfma_f32_16x16x32_bf16 v[108:111], v[212:215], v[192:195], v[108:111]
    v_mul_f32 v13, v105, v13
    v_mul_f32 v14, v105, v14
    v_mfma_f32_16x16x32_bf16 v[40:43], a[32:35], v[192:195], v[40:43]
    v_mul_f32 v15, v105, v15
    v_cvt_pk_bf16_f32 v166, v12, v13
    v_mfma_f32_16x16x32_bf16 v[44:47], a[36:39], v[192:195], v[44:47]
    v_cvt_pk_bf16_f32 v167, v14, v15
    v_mul_f32 v16, v105, v16
    v_mfma_f32_16x16x32_bf16 v[48:51], a[40:43], v[192:195], v[48:51]
    buffer_load_dwordx4 v245, s[40:43], s78 offen offset:1024 lds
    buffer_store_dwordx4 v[164:167], v248, s[44:47], s79 offen sc1
    v_mfma_f32_16x16x32_bf16 v[52:55], a[44:47], v[192:195], v[52:55]
    v_mul_f32 v17, v105, v17
    v_mul_f32 v18, v105, v18
    v_mfma_f32_16x16x32_bf16 v[56:59], a[48:51], v[192:195], v[56:59]
    v_mul_f32 v19, v105, v19
    v_cvt_pk_bf16_f32 v168, v16, v17
    v_mfma_f32_16x16x32_bf16 v[60:63], a[52:55], v[192:195], v[60:63]
    v_cvt_pk_bf16_f32 v169, v18, v19
    v_mul_f32 v20, v105, v20
    v_mfma_f32_16x16x32_bf16 v[64:67], a[56:59], v[192:195], v[64:67]
    v_mul_f32 v21, v105, v21
    v_mul_f32 v22, v105, v22
    v_mul_f32 v23, v105, v23
    v_cvt_pk_bf16_f32 v170, v20, v21
    v_cvt_pk_bf16_f32 v171, v22, v23
    v_mfma_f32_16x16x32_bf16 v[68:71], a[60:63], v[192:195], v[68:71]
    buffer_store_dwordx4 v[168:171], v248, s[44:47], s79 offen offset:1024 sc1
    v_cvt_pk_bf16_f32 v196, v180, v181
    v_cvt_pk_bf16_f32 v197, v182, v183
    v_mfma_f32_16x16x32_bf16 v[180:183], a[0:3], v[148:151], v[208:211]
    v_exp_f32 v184, v184
    v_mfma_f32_16x16x32_bf16 v[180:183], a[4:7], v[152:155], v[180:183]
    v_exp_f32 v185, v185
    v_mfma_f32_16x16x32_bf16 v[180:183], a[8:11], v[156:159], v[180:183]
    v_exp_f32 v186, v186
    v_exp_f32 v187, v187
    v_mul_f32 v24, v105, v24
    v_mul_f32 v25, v105, v25
    v_mul_f32 v26, v105, v26
    v_mul_f32 v27, v105, v27
    v_cvt_pk_bf16_f32 v188, v24, v25
    v_cvt_pk_bf16_f32 v189, v26, v27
    v_mul_f32 v28, v105, v28
    v_mul_f32 v29, v105, v29
    v_mul_f32 v30, v105, v30
    v_mul_f32 v31, v105, v31
    v_cvt_pk_bf16_f32 v190, v28, v29
    v_cvt_pk_bf16_f32 v191, v30, v31
    v_mfma_f32_16x16x32_bf16 v[180:183], a[12:15], v[160:163], v[180:183]
    buffer_store_dwordx4 v[188:191], v248, s[44:47], s79 offen offset:2048 sc1
    v_cvt_pk_bf16_f32 v198, v184, v185
    v_cvt_pk_bf16_f32 v199, v186, v187
    v_mfma_f32_16x16x32_bf16 v[184:187], a[16:19], v[148:151], v[208:211]
    v_exp_f32 v172, v172
    v_mfma_f32_16x16x32_bf16 v[184:187], a[20:23], v[152:155], v[184:187]
    v_exp_f32 v173, v173
    v_exp_f32 v174, v174
    v_exp_f32 v175, v175
    v_exp_f32 v176, v176
    v_exp_f32 v177, v177
    v_exp_f32 v178, v178
    v_exp_f32 v179, v179
    v_mfma_f32_16x16x32_bf16 v[184:187], a[24:27], v[156:159], v[184:187]
    v_mul_f32 v32, v105, v32
    v_mul_f32 v33, v105, v33
    v_mul_f32 v34, v105, v34
    v_mul_f32 v35, v105, v35
    v_cvt_pk_bf16_f32 v204, v32, v33
    v_cvt_pk_bf16_f32 v205, v34, v35
    v_mul_f32 v36, v105, v36
    v_mul_f32 v37, v105, v37
    v_mul_f32 v38, v105, v38
    v_mul_f32 v39, v105, v39
    v_cvt_pk_bf16_f32 v206, v36, v37
    v_cvt_pk_bf16_f32 v207, v38, v39
    v_cvt_pk_bf16_f32 v192, v172, v173
    v_cvt_pk_bf16_f32 v193, v174, v175
    v_cvt_pk_bf16_f32 v194, v176, v177
    v_cvt_pk_bf16_f32 v195, v178, v179
    v_mfma_f32_16x16x32_bf16 v[184:187], a[28:31], v[160:163], v[184:187]
    buffer_store_dwordx4 v[204:207], v248, s[44:47], s79 offen offset:3072 sc1
    v_cmp_nge_f32 s[90:91], s85, v104
    v_mfma_f32_16x16x32_bf16 v[108:111], v[212:215], v[192:195], v[108:111]
    s_add_u32 s79, s86, 4096
    v_exp_f32 v180, v180
    v_mfma_f32_16x16x32_bf16 v[40:43], a[64:67], v[192:195], v[40:43]
    v_exp_f32 v181, v181
    v_mfma_f32_16x16x32_bf16 v[44:47], a[68:71], v[192:195], v[44:47]
    v_exp_f32 v182, v182
    v_mfma_f32_16x16x32_bf16 v[48:51], a[72:75], v[192:195], v[48:51]
    v_exp_f32 v183, v183
    v_mfma_f32_16x16x32_bf16 v[52:55], a[76:79], v[192:195], v[52:55]
    v_rcp_f32 v109, v108
    v_mfma_f32_16x16x32_bf16 v[56:59], a[80:83], v[192:195], v[56:59]
    v_mul_f32 v40, v109, v40
    v_mul_f32 v41, v109, v41
    v_mfma_f32_16x16x32_bf16 v[60:63], a[84:87], v[192:195], v[60:63]
    v_mul_f32 v42, v109, v42
    v_mul_f32 v43, v109, v43
    v_mfma_f32_16x16x32_bf16 v[64:67], a[88:91], v[192:195], v[64:67]
    v_cvt_pk_bf16_f32 v172, v40, v41
    v_cvt_pk_bf16_f32 v173, v42, v43
    v_mfma_f32_16x16x32_bf16 v[68:71], a[92:95], v[192:195], v[68:71]
    v_mul_f32 v44, v109, v44
    v_mul_f32 v45, v109, v45
    v_mfma_f32_16x16x32_bf16 v[112:115], v[212:215], v[196:199], v[112:115]
    v_mul_f32 v46, v109, v46
    v_mul_f32 v47, v109, v47
    v_mfma_f32_16x16x32_bf16 v[72:75], a[32:35], v[196:199], v[72:75]
    v_cvt_pk_bf16_f32 v174, v44, v45
    v_cvt_pk_bf16_f32 v175, v46, v47
    v_mfma_f32_16x16x32_bf16 v[76:79], a[36:39], v[196:199], v[76:79]
    buffer_store_dwordx4 v[172:175], v248, s[44:47], s79 offen sc1
    v_cvt_pk_bf16_f32 v200, v180, v181
    v_mfma_f32_16x16x32_bf16 v[80:83], a[40:43], v[196:199], v[80:83]
    v_exp_f32 v184, v184
    v_mfma_f32_16x16x32_bf16 v[84:87], a[44:47], v[196:199], v[84:87]
    v_exp_f32 v185, v185
    v_mfma_f32_16x16x32_bf16 v[88:91], a[48:51], v[196:199], v[88:91]
    v_exp_f32 v186, v186
    v_mfma_f32_16x16x32_bf16 v[92:95], a[52:55], v[196:199], v[92:95]
    v_exp_f32 v187, v187
    v_mfma_f32_16x16x32_bf16 v[96:99], a[56:59], v[196:199], v[96:99]
    v_cvt_pk_bf16_f32 v201, v182, v183
    v_cvt_pk_bf16_f32 v202, v184, v185
    v_cvt_pk_bf16_f32 v203, v186, v187
    v_mfma_f32_16x16x32_bf16 v[100:103], a[60:63], v[196:199], v[100:103]
    v_mul_f32 v48, v109, v48
    v_mul_f32 v49, v109, v49
    v_mul_f32 v50, v109, v50
    v_mul_f32 v51, v109, v51
    v_cvt_pk_bf16_f32 v176, v48, v49
    v_cvt_pk_bf16_f32 v177, v50, v51
    v_mul_f32 v52, v109, v52
    v_mul_f32 v53, v109, v53
    v_mul_f32 v54, v109, v54
    v_mul_f32 v55, v109, v55
    v_cvt_pk_bf16_f32 v178, v52, v53
    v_cvt_pk_bf16_f32 v179, v54, v55
    v_mfma_f32_16x16x32_bf16 v[112:115], v[212:215], v[200:203], v[112:115]
    buffer_store_dwordx4 v[176:179], v248, s[44:47], s79 offen offset:1024 sc1
    v_mul_f32 v56, v109, v56
    v_mfma_f32_16x16x32_bf16 v[72:75], a[64:67], v[200:203], v[72:75]
    v_mul_f32 v57, v109, v57
    v_mul_f32 v58, v109, v58
    v_mfma_f32_16x16x32_bf16 v[76:79], a[68:71], v[200:203], v[76:79]
    v_mul_f32 v59, v109, v59
    v_cvt_pk_bf16_f32 v192, v56, v57
    v_mfma_f32_16x16x32_bf16 v[80:83], a[72:75], v[200:203], v[80:83]
    v_cvt_pk_bf16_f32 v193, v58, v59
    v_mul_f32 v60, v109, v60
    v_mul_f32 v61, v109, v61
    v_mul_f32 v62, v109, v62
    v_mul_f32 v63, v109, v63
    v_cvt_pk_bf16_f32 v194, v60, v61
    v_cvt_pk_bf16_f32 v195, v62, v63
    v_mfma_f32_16x16x32_bf16 v[84:87], a[76:79], v[200:203], v[84:87]
    buffer_store_dwordx4 v[192:195], v248, s[44:47], s79 offen offset:2048 sc1
    v_mul_f32 v64, v109, v64
    v_mfma_f32_16x16x32_bf16 v[88:91], a[80:83], v[200:203], v[88:91]
    v_mul_f32 v65, v109, v65
    v_mul_f32 v66, v109, v66
    v_mfma_f32_16x16x32_bf16 v[92:95], a[84:87], v[200:203], v[92:95]
    v_mul_f32 v67, v109, v67
    v_cvt_pk_bf16_f32 v208, v64, v65
    v_mfma_f32_16x16x32_bf16 v[96:99], a[88:91], v[200:203], v[96:99]
    v_cvt_pk_bf16_f32 v209, v66, v67
    v_mul_f32 v68, v109, v68
    v_mul_f32 v69, v109, v69
    v_mul_f32 v70, v109, v70
    v_mul_f32 v71, v109, v71
    v_cvt_pk_bf16_f32 v210, v68, v69
    v_cvt_pk_bf16_f32 v211, v70, v71
    v_mfma_f32_16x16x32_bf16 v[100:103], a[92:95], v[200:203], v[100:103]
    buffer_store_dwordx4 v[208:211], v248, s[44:47], s79 offen offset:3072 sc1
    v_rcp_f32 v113, v112
    s_nop 0
    v_pk_mul_f32 v[72:73], v[72:73], v[112:113] op_sel:[0,1] op_sel_hi:[1,1]
    v_pk_mul_f32 v[74:75], v[74:75], v[112:113] op_sel:[0,1] op_sel_hi:[1,1]
    v_cvt_pk_bf16_f32 v180, v72, v73
    v_cvt_pk_bf16_f32 v181, v74, v75
    v_pk_mul_f32 v[76:77], v[76:77], v[112:113] op_sel:[0,1] op_sel_hi:[1,1]
    v_pk_mul_f32 v[78:79], v[78:79], v[112:113] op_sel:[0,1] op_sel_hi:[1,1]
    v_cvt_pk_bf16_f32 v182, v76, v77
    v_cvt_pk_bf16_f32 v183, v78, v79
    s_add_u32 s79, s86, 8192
    v_pk_mul_f32 v[80:81], v[80:81], v[112:113] op_sel:[0,1] op_sel_hi:[1,1]
    v_pk_mul_f32 v[82:83], v[82:83], v[112:113] op_sel:[0,1] op_sel_hi:[1,1]
    v_cvt_pk_bf16_f32 v184, v80, v81
    v_cvt_pk_bf16_f32 v185, v82, v83
    v_pk_mul_f32 v[84:85], v[84:85], v[112:113] op_sel:[0,1] op_sel_hi:[1,1]
    v_pk_mul_f32 v[86:87], v[86:87], v[112:113] op_sel:[0,1] op_sel_hi:[1,1]
    v_cvt_pk_bf16_f32 v186, v84, v85
    v_cvt_pk_bf16_f32 v187, v86, v87
    v_pk_mul_f32 v[88:89], v[88:89], v[112:113] op_sel:[0,1] op_sel_hi:[1,1]
    v_pk_mul_f32 v[90:91], v[90:91], v[112:113] op_sel:[0,1] op_sel_hi:[1,1]
    v_cvt_pk_bf16_f32 v196, v88, v89
    v_cvt_pk_bf16_f32 v197, v90, v91
    v_pk_mul_f32 v[92:93], v[92:93], v[112:113] op_sel:[0,1] op_sel_hi:[1,1]
    v_pk_mul_f32 v[94:95], v[94:95], v[112:113] op_sel:[0,1] op_sel_hi:[1,1]
    v_cvt_pk_bf16_f32 v198, v92, v93
    v_cvt_pk_bf16_f32 v199, v94, v95
    v_pk_mul_f32 v[96:97], v[96:97], v[112:113] op_sel:[0,1] op_sel_hi:[1,1]
    v_pk_mul_f32 v[98:99], v[98:99], v[112:113] op_sel:[0,1] op_sel_hi:[1,1]
    v_cvt_pk_bf16_f32 v200, v96, v97
    v_cvt_pk_bf16_f32 v201, v98, v99
    v_pk_mul_f32 v[100:101], v[100:101], v[112:113] op_sel:[0,1] op_sel_hi:[1,1]
    v_pk_mul_f32 v[102:103], v[102:103], v[112:113] op_sel:[0,1] op_sel_hi:[1,1]
    v_cvt_pk_bf16_f32 v202, v100, v101
    v_cvt_pk_bf16_f32 v203, v102, v103
    v_cmp_nge_f32 s[92:93], s85, v108
    v_cmp_nge_f32 s[94:95], s85, v112
L_pg6:
    s_cbranch_execz L_warmed
    buffer_store_dwordx4 v[180:183], v248, s[44:47], s79 offen sc1
    buffer_store_dwordx4 v[184:187], v248, s[44:47], s79 offen offset:1024 sc1
    buffer_store_dwordx4 v[196:199], v248, s[44:47], s79 offen offset:2048 sc1
    buffer_store_dwordx4 v[200:203], v248, s[44:47], s79 offen offset:3072 sc1
    s_waitcnt lgkmcnt(0)
    s_barrier
    s_or_b64 s[90:91], s[90:91], s[92:93]
    s_or_b64 s[90:91], s[90:91], s[94:95]
    s_cbranch_scc1 L_slow
L_back:
    s_and_b32 s83, s20, 0
    s_lshl_b32 s83, s83, 1
    s_xor_b32 s82, s74, s83
    s_lshl_b32 s82, s82, 5
    v_subrev_u32 v240, 98304, v220
    v_xor_b32 v240, s82, v240
    v_xor_b32 v216, 0, v240
    v_xor_b32 v217, 32, v240
    v_xor_b32 v218, 64, v240
    v_xor_b32 v219, 96, v240
    v_xor_b32 v220, 128, v240
    v_xor_b32 v221, 160, v240
    v_xor_b32 v222, 192, v240
    v_xor_b32 v223, 224, v240
    v_add_u32 v224, 65536, v216
    v_add_u32 v225, 65536, v217
    v_add_u32 v226, 65536, v218
    v_add_u32 v227, 65536, v219
    v_add_u32 v228, 65536, v220
    v_add_u32 v229, 65536, v221
    v_add_u32 v230, 65536, v222
    v_add_u32 v231, 65536, v223
    v_add_u32 v232, 65536, v224
    v_add_u32 v233, 65536, v225
    v_add_u32 v234, 65536, v226
    v_add_u32 v235, 65536, v227
    v_add_u32 v236, 65536, v228
    v_add_u32 v237, 65536, v229
    v_add_u32 v238, 65536, v230
    v_add_u32 v239, 65536, v231
    v_mov_b32 v6, s80
    v_mov_b32 v4, 0x7ffffff0
    v_mov_b32 v7, 0
    ds_read_b64_tr_b16 a[0:1], v224 offset:0
    ds_read_b64_tr_b16 a[2:3], v224 offset:4096
    ds_read_b64_tr_b16 a[4:5], v224 offset:8192
    ds_read_b64_tr_b16 a[6:7], v224 offset:12288
    ds_read_b64_tr_b16 a[8:9], v224 offset:16384
    ds_read_b64_tr_b16 a[10:11], v224 offset:20480
    ds_read_b64_tr_b16 a[12:13], v224 offset:24576
    ds_read_b64_tr_b16 a[14:15], v224 offset:28672
    s_waitcnt lgkmcnt(6)
    v_mfma_f32_16x16x32_bf16 v[8:11], a[0:3], v[164:167], 0
    s_waitcnt lgkmcnt(4)
    s_xor_b32 s82, s74, 1
    ds_read_b64_tr_b16 a[16:17], v225 offset:0
    ds_read_b64_tr_b16 a[224:225], v217 offset:57344
    v_mfma_f32_16x16x32_bf16 v[8:11], a[4:7], v[168:171], v[8:11]
    s_waitcnt lgkmcnt(4)
    s_sub_i32 s82, s82, s74
    ds_read_b64_tr_b16 a[18:19], v225 offset:4096
    ds_read_b64_tr_b16 a[226:227], v217 offset:61440
    v_mfma_f32_16x16x32_bf16 v[8:11], a[8:11], v[188:191], v[8:11]
    s_waitcnt lgkmcnt(4)
    s_mul_i32 s82, s82, 172032
    ds_read_b64_tr_b16 a[20:21], v225 offset:8192
    ds_read_b64_tr_b16 a[228:229], v225 offset:32768
    v_mfma_f32_16x16x32_bf16 v[8:11], a[12:15], v[204:207], v[8:11]
    s_add_u32 s82, s82, s89
    ds_read_b64_tr_b16 a[22:23], v225 offset:12288
    ds_read_b64_tr_b16 a[230:231], v225 offset:36864
    v_mfma_f32_16x16x32_bf16 v[40:43], a[0:3], v[172:175], 0
    s_add_u32 s56, s82, 0
    ds_read_b64_tr_b16 a[24:25], v225 offset:16384
    ds_read_b64_tr_b16 a[232:233], v217 offset:49152
    v_mfma_f32_16x16x32_bf16 v[40:43], a[4:7], v[176:179], v[40:43]
    s_xor_b32 s82, s74, 2
    ds_read_b64_tr_b16 a[26:27], v225 offset:20480
    ds_read_b64_tr_b16 a[234:235], v217 offset:53248
    v_mfma_f32_16x16x32_bf16 v[40:43], a[8:11], v[192:195], v[40:43]
    s_sub_i32 s82, s82, s74
    ds_read_b64_tr_b16 a[28:29], v225 offset:24576
    ds_read_b64_tr_b16 a[30:31], v225 offset:28672
    v_mfma_f32_16x16x32_bf16 v[40:43], a[12:15], v[208:211], v[40:43]
    s_mul_i32 s82, s82, 172032
    ds_read_b64_tr_b16 a[32:33], v226 offset:0
    ds_read_b64_tr_b16 a[236:237], v225 offset:40960
    v_mfma_f32_16x16x32_bf16 v[72:75], a[0:3], v[180:183], 0
    s_add_u32 s82, s82, s89
    ds_read_b64_tr_b16 a[34:35], v226 offset:4096
    ds_read_b64_tr_b16 a[238:239], v225 offset:45056
    v_mfma_f32_16x16x32_bf16 v[72:75], a[4:7], v[184:187], v[72:75]
    s_add_u32 s57, s82, 1536
    ds_read_b64_tr_b16 a[36:37], v226 offset:8192
    ds_read_b64_tr_b16 a[240:241], v218 offset:57344
    v_mfma_f32_16x16x32_bf16 v[72:75], a[8:11], v[196:199], v[72:75]
    s_xor_b32 s82, s74, 3
    ds_read_b64_tr_b16 a[38:39], v226 offset:12288
    ds_read_b64_tr_b16 a[242:243], v218 offset:61440
    v_mfma_f32_16x16x32_bf16 v[72:75], a[12:15], v[200:203], v[72:75]
    s_waitcnt lgkmcnt(15)
    s_sub_i32 s82, s82, s74
    ds_read_b64_tr_b16 a[40:41], v226 offset:16384
    ds_read_b64_tr_b16 a[244:245], v226 offset:32768
    v_mfma_f32_16x16x32_bf16 v[12:15], a[16:19], v[164:167], 0
    s_mul_i32 s82, s82, 172032
    ds_read_b64_tr_b16 a[42:43], v226 offset:20480
    ds_read_b64_tr_b16 a[246:247], v226 offset:36864
    v_mfma_f32_16x16x32_bf16 v[12:15], a[20:23], v[168:171], v[12:15]
    s_waitcnt lgkmcnt(15)
    s_add_u32 s82, s82, s89
    ds_read_b64_tr_b16 a[44:45], v226 offset:24576
    ds_read_b64_tr_b16 a[248:249], v218 offset:49152
    v_mfma_f32_16x16x32_bf16 v[12:15], a[24:27], v[188:191], v[12:15]
    s_waitcnt lgkmcnt(14)
    s_add_u32 s58, s82, 3072
    ds_read_b64_tr_b16 a[46:47], v226 offset:28672
    ds_read_b64_tr_b16 a[250:251], v218 offset:53248
    v_mfma_f32_16x16x32_bf16 v[12:15], a[28:31], v[204:207], v[12:15]
    s_xor_b32 s82, s74, 4
    ds_read_b64_tr_b16 a[0:1], v227 offset:0
    ds_read_b64_tr_b16 a[252:253], v226 offset:40960
    v_mfma_f32_16x16x32_bf16 v[44:47], a[16:19], v[172:175], 0
    s_sub_i32 s82, s82, s74
    ds_read_b64_tr_b16 a[2:3], v227 offset:4096
    ds_read_b64_tr_b16 a[254:255], v226 offset:45056
    v_mfma_f32_16x16x32_bf16 v[44:47], a[20:23], v[176:179], v[44:47]
    s_mul_i32 s82, s82, 172032
    ds_read_b64_tr_b16 a[4:5], v227 offset:8192
    ds_read_b64_tr_b16 v[116:117], v219 offset:57344
    v_mfma_f32_16x16x32_bf16 v[44:47], a[24:27], v[192:195], v[44:47]
    s_add_u32 s82, s82, s89
    ds_read_b64_tr_b16 a[6:7], v227 offset:12288
    ds_read_b64_tr_b16 v[118:119], v219 offset:61440
    v_mfma_f32_16x16x32_bf16 v[44:47], a[28:31], v[208:211], v[44:47]
    s_add_u32 s59, s82, 4608
    ds_read_b64_tr_b16 a[8:9], v227 offset:16384
    ds_read_b64_tr_b16 v[120:121], v227 offset:32768
    v_mfma_f32_16x16x32_bf16 v[76:79], a[16:19], v[180:183], 0
    s_xor_b32 s82, s74, 5
    ds_read_b64_tr_b16 a[10:11], v227 offset:20480
    ds_read_b64_tr_b16 v[122:123], v227 offset:36864
    v_mfma_f32_16x16x32_bf16 v[76:79], a[20:23], v[184:187], v[76:79]
    s_sub_i32 s82, s82, s74
    ds_read_b64_tr_b16 a[12:13], v227 offset:24576
    ds_read_b64_tr_b16 v[124:125], v219 offset:49152
    v_mfma_f32_16x16x32_bf16 v[76:79], a[24:27], v[196:199], v[76:79]
    s_mul_i32 s82, s82, 172032
    ds_read_b64_tr_b16 a[14:15], v227 offset:28672
    ds_read_b64_tr_b16 v[126:127], v219 offset:53248
    v_mfma_f32_16x16x32_bf16 v[76:79], a[28:31], v[200:203], v[76:79]
    s_waitcnt lgkmcnt(15)
    s_add_u32 s82, s82, s89
    ds_read_b64_tr_b16 a[16:17], v228 offset:0
    ds_read_b64_tr_b16 v[128:129], v227 offset:40960
    v_mfma_f32_16x16x32_bf16 v[16:19], a[32:35], v[164:167], 0
    s_add_u32 s60, s82, 6144
    ds_read_b64_tr_b16 a[18:19], v228 offset:4096
    ds_read_b64_tr_b16 v[130:131], v227 offset:45056
    v_mfma_f32_16x16x32_bf16 v[16:19], a[36:39], v[168:171], v[16:19]
    s_xor_b32 s82, s74, 6
    ds_read_b64_tr_b16 a[20:21], v228 offset:8192
    ds_read_b64_tr_b16 v[132:133], v220 offset:57344
    v_mfma_f32_16x16x32_bf16 v[16:19], a[40:43], v[188:191], v[16:19]
    s_sub_i32 s82, s82, s74
    ds_read_b64_tr_b16 a[22:23], v228 offset:12288
    ds_read_b64_tr_b16 v[134:135], v220 offset:61440
    v_mfma_f32_16x16x32_bf16 v[16:19], a[44:47], v[204:207], v[16:19]
    s_mul_i32 s82, s82, 172032
    ds_read_b64_tr_b16 a[24:25], v228 offset:16384
    ds_read_b64_tr_b16 v[136:137], v228 offset:32768
    v_mfma_f32_16x16x32_bf16 v[48:51], a[32:35], v[172:175], 0
    s_add_u32 s82, s82, s89
    ds_read_b64_tr_b16 a[26:27], v228 offset:20480
    ds_read_b64_tr_b16 v[138:139], v228 offset:36864
    v_mfma_f32_16x16x32_bf16 v[48:51], a[36:39], v[176:179], v[48:51]
    s_add_u32 s61, s82, 7680
    ds_read_b64_tr_b16 a[28:29], v228 offset:24576
    ds_read_b64_tr_b16 v[140:141], v220 offset:49152
    v_mfma_f32_16x16x32_bf16 v[48:51], a[40:43], v[192:195], v[48:51]
    s_waitcnt vmcnt(18)
    s_xor_b32 s82, s74, 7
    ds_read_b64_tr_b16 a[30:31], v228 offset:28672
    v_cmp_ne_u32 vcc, s0, v247
    v_mfma_f32_16x16x32_bf16 v[48:51], a[44:47], v[208:211], v[48:51]
    s_sub_i32 s82, s82, s74
    ds_read_b64_tr_b16 v[142:143], v220 offset:53248
    ds_read_b64_tr_b16 v[144:145], v228 offset:40960
    v_mfma_f32_16x16x32_bf16 v[80:83], a[32:35], v[180:183], 0
    s_mul_i32 s82, s82, 172032
    ds_read_b64_tr_b16 a[32:33], v229 offset:0
    ds_read_b64_tr_b16 v[146:147], v228 offset:45056
    v_mfma_f32_16x16x32_bf16 v[80:83], a[36:39], v[184:187], v[80:83]
    s_and_b32 s83, vcc_lo, 255
    s_cselect_b32 s3, s0, s80
    ds_read_b64_tr_b16 a[34:35], v229 offset:4096
    ds_read_b64_tr_b16 v[148:149], v221 offset:57344
    v_mfma_f32_16x16x32_bf16 v[80:83], a[40:43], v[196:199], v[80:83]
    s_add_u32 s82, s82, s89
    ds_read_b64_tr_b16 a[36:37], v229 offset:8192
    ds_read_b64_tr_b16 v[150:151], v221 offset:61440
    v_mfma_f32_16x16x32_bf16 v[80:83], a[44:47], v[200:203], v[80:83]
    s_waitcnt lgkmcnt(15)
    s_add_u32 s62, s82, 9216
    ds_read_b64_tr_b16 a[38:39], v229 offset:12288
    ds_read_b64_tr_b16 v[152:153], v229 offset:32768
    v_mfma_f32_16x16x32_bf16 v[20:23], a[0:3], v[164:167], 0
    s_waitcnt vmcnt(0)
    ds_read_b64_tr_b16 v[154:155], v229 offset:36864
    s_cmp_lg_u32 s3, s80
    s_cbranch_scc1 L_far
    s_mov_b64 exec, 1
    buffer_store_dword v6, v7, s[44:47], s1 offen
    s_mov_b64 exec, -1
L_farback:
    v_mfma_f32_16x16x32_bf16 v[20:23], a[4:7], v[168:171], v[20:23]
    ds_read_b64_tr_b16 a[40:41], v229 offset:16384
    ds_read_b64_tr_b16 v[156:157], v221 offset:49152
    v_mfma_f32_16x16x32_bf16 v[20:23], a[8:11], v[188:191], v[20:23]
    ds_read_b64_tr_b16 a[42:43], v229 offset:20480
    ds_read_b64_tr_b16 v[158:159], v221 offset:53248
    v_mfma_f32_16x16x32_bf16 v[20:23], a[12:15], v[204:207], v[20:23]
    ds_read_b64_tr_b16 a[44:45], v229 offset:24576
    ds_read_b64_tr_b16 v[160:161], v229 offset:40960
    v_mfma_f32_16x16x32_bf16 v[52:55], a[0:3], v[172:175], 0
    ds_read_b64_tr_b16 a[46:47], v229 offset:28672
    ds_read_b64_tr_b16 v[162:163], v229 offset:45056
    v_mfma_f32_16x16x32_bf16 v[52:55], a[4:7], v[176:179], v[52:55]
    ds_read_b64_tr_b16 v[104:105], v222 offset:57344
    ds_read_b64_tr_b16 v[106:107], v222 offset:61440
    v_mfma_f32_16x16x32_bf16 v[52:55], a[8:11], v[192:195], v[52:55]
    ds_read_b64_tr_b16 v[108:109], v230 offset:32768
    ds_read_b64_tr_b16 v[110:111], v230 offset:36864
    v_mfma_f32_16x16x32_bf16 v[52:55], a[12:15], v[208:211], v[52:55]
    ds_read_b64_tr_b16 v[112:113], v222 offset:49152
    ds_read_b64_tr_b16 v[114:115], v222 offset:53248
    v_mfma_f32_16x16x32_bf16 v[84:87], a[0:3], v[180:183], 0
    ds_read_b64_tr_b16 a[0:1], v230 offset:0
    ds_read_b64_tr_b16 v[212:213], v230 offset:40960
    v_mfma_f32_16x16x32_bf16 v[84:87], a[4:7], v[184:187], v[84:87]
    ds_read_b64_tr_b16 a[2:3], v230 offset:4096
    ds_read_b64_tr_b16 v[214:215], v230 offset:45056
    v_mfma_f32_16x16x32_bf16 v[84:87], a[8:11], v[196:199], v[84:87]
    ds_read_b64_tr_b16 a[4:5], v230 offset:8192
    ds_read_b64_tr_b16 a[48:49], v223 offset:57344
    v_mfma_f32_16x16x32_bf16 v[84:87], a[12:15], v[200:203], v[84:87]
    ds_read_b64_tr_b16 a[6:7], v230 offset:12288
    ds_read_b64_tr_b16 a[50:51], v223 offset:61440
    v_mfma_f32_16x16x32_bf16 v[24:27], a[16:19], v[164:167], 0
    ds_read_b64_tr_b16 a[8:9], v230 offset:16384
    ds_read_b64_tr_b16 a[52:53], v231 offset:32768
    v_mfma_f32_16x16x32_bf16 v[24:27], a[20:23], v[168:171], v[24:27]
    s_waitcnt lgkmcnt(15)
    ds_read_b64_tr_b16 a[10:11], v230 offset:20480
    ds_read_b64_tr_b16 a[54:55], v231 offset:36864
    v_mfma_f32_16x16x32_bf16 v[24:27], a[24:27], v[188:191], v[24:27]
    ds_read_b64_tr_b16 a[12:13], v230 offset:24576
    ds_read_b64_tr_b16 a[56:57], v223 offset:49152
    v_mfma_f32_16x16x32_bf16 v[24:27], a[28:31], v[204:207], v[24:27]
    ds_read_b64_tr_b16 a[14:15], v230 offset:28672
    ds_read_b64_tr_b16 a[58:59], v223 offset:53248
    v_mfma_f32_16x16x32_bf16 v[56:59], a[16:19], v[172:175], 0
    ds_read_b64_tr_b16 a[60:61], v231 offset:40960
    ds_read_b64_tr_b16 a[62:63], v231 offset:45056
    v_mfma_f32_16x16x32_bf16 v[56:59], a[20:23], v[176:179], v[56:59]
    ds_read_b64_tr_b16 a[208:209], v216 offset:57344
    ds_read_b64_tr_b16 a[210:211], v216 offset:61440
    v_mfma_f32_16x16x32_bf16 v[56:59], a[24:27], v[192:195], v[56:59]
    ds_read_b64_tr_b16 a[212:213], v224 offset:32768
    buffer_load_dword v5, v246, s[44:47], 0 offen sc1
    v_mfma_f32_16x16x32_bf16 v[56:59], a[28:31], v[208:211], v[56:59]
    ds_read_b64_tr_b16 a[214:215], v224 offset:36864
    ds_read_b64_tr_b16 a[216:217], v216 offset:49152
    v_mfma_f32_16x16x32_bf16 v[88:91], a[16:19], v[180:183], 0
    ds_read_b64_tr_b16 a[16:17], v231 offset:0
    ds_read_b64_tr_b16 a[218:219], v216 offset:53248
    v_mfma_f32_16x16x32_bf16 v[88:91], a[20:23], v[184:187], v[88:91]
    ds_read_b64_tr_b16 a[18:19], v231 offset:4096
    ds_read_b64_tr_b16 a[220:221], v224 offset:40960
    v_mfma_f32_16x16x32_bf16 v[88:91], a[24:27], v[196:199], v[88:91]
    ds_read_b64_tr_b16 a[20:21], v231 offset:8192
    ds_read_b64_tr_b16 a[222:223], v224 offset:45056
    v_mfma_f32_16x16x32_bf16 v[88:91], a[28:31], v[200:203], v[88:91]
    ds_read_b64_tr_b16 a[22:23], v231 offset:12288
    v_lshrrev_b32 v241, 1, v248
    v_mfma_f32_16x16x32_bf16 v[28:31], a[32:35], v[164:167], 0
    ds_read_b64_tr_b16 a[24:25], v231 offset:16384
    v_mfma_f32_16x16x32_bf16 v[28:31], a[36:39], v[168:171], v[28:31]
    ds_read_b64_tr_b16 a[26:27], v231 offset:20480
    v_mfma_f32_16x16x32_bf16 v[28:31], a[40:43], v[188:191], v[28:31]
    ds_read_b64_tr_b16 a[28:29], v231 offset:24576
    v_mfma_f32_16x16x32_bf16 v[28:31], a[44:47], v[204:207], v[28:31]
    ds_read_b64_tr_b16 a[30:31], v231 offset:28672
    v_mfma_f32_16x16x32_bf16 v[60:63], a[32:35], v[172:175], 0
    s_waitcnt vmcnt(0)
    v_cmp_ne_u32 vcc, s80, v5
    v_mfma_f32_16x16x32_bf16 v[60:63], a[36:39], v[176:179], v[60:63]
    s_add_u32 s79, s97, 0
    v_mfma_f32_16x16x32_bf16 v[60:63], a[40:43], v[192:195], v[60:63]
    s_cbranch_vccnz L_wait1
L_go1:
    v_mfma_f32_16x16x32_bf16 v[60:63], a[44:47], v[208:211], v[60:63]
    v_mfma_f32_16x16x32_bf16 v[92:95], a[32:35], v[180:183], 0
    buffer_load_dwordx4 a[64:67], v248, s[44:47], s79 offen sc1
    v_mfma_f32_16x16x32_bf16 v[92:95], a[36:39], v[184:187], v[92:95]
    v_mfma_f32_16x16x32_bf16 v[92:95], a[40:43], v[196:199], v[92:95]
    v_mfma_f32_16x16x32_bf16 v[92:95], a[44:47], v[200:203], v[92:95]
    s_waitcnt lgkmcnt(1)
    v_mfma_f32_16x16x32_bf16 v[32:35], a[0:3], v[164:167], 0
    buffer_load_dwordx4 a[68:71], v248, s[44:47], s79 offen offset:1024 sc1
    v_mfma_f32_16x16x32_bf16 v[32:35], a[4:7], v[168:171], v[32:35]
    v_mfma_f32_16x16x32_bf16 v[32:35], a[8:11], v[188:191], v[32:35]
    v_mfma_f32_16x16x32_bf16 v[32:35], a[12:15], v[204:207], v[32:35]
    v_mfma_f32_16x16x32_bf16 v[64:67], a[0:3], v[172:175], 0
    buffer_load_dwordx4 a[72:75], v248, s[44:47], s79 offen offset:2048 sc1
    v_mfma_f32_16x16x32_bf16 v[64:67], a[4:7], v[176:179], v[64:67]
    v_mfma_f32_16x16x32_bf16 v[64:67], a[8:11], v[192:195], v[64:67]
    v_mfma_f32_16x16x32_bf16 v[64:67], a[12:15], v[208:211], v[64:67]
    v_mfma_f32_16x16x32_bf16 v[96:99], a[0:3], v[180:183], 0
    s_barrier
    buffer_load_dwordx4 a[76:79], v248, s[44:47], s79 offen offset:3072 sc1
    ds_read_b64_tr_b16 a[0:1], v217 offset:40960
    v_mfma_f32_16x16x32_bf16 v[96:99], a[4:7], v[184:187], v[96:99]
    ds_read_b64_tr_b16 a[2:3], v217 offset:45056
    ds_read_b64_tr_b16 a[4:5], v225 offset:49152
    v_mfma_f32_16x16x32_bf16 v[96:99], a[8:11], v[196:199], v[96:99]
    ds_read_b64_tr_b16 a[6:7], v225 offset:53248
    ds_read_b64_tr_b16 a[8:9], v217 offset:24576
    v_mfma_f32_16x16x32_bf16 v[96:99], a[12:15], v[200:203], v[96:99]
    ds_read_b64_tr_b16 a[10:11], v217 offset:28672
    ds_read_b64_tr_b16 a[12:13], v225 offset:57344
    v_mfma_f32_16x16x32_bf16 v[36:39], a[16:19], v[164:167], 0
    ds_read_b64_tr_b16 a[14:15], v225 offset:61440
    ds_read_b64_tr_b16 v[164:165], v217 offset:0
    v_mfma_f32_16x16x32_bf16 v[36:39], a[20:23], v[168:171], v[36:39]
    ds_read_b64_tr_b16 v[166:167], v217 offset:4096
    ds_read_b64_tr_b16 v[168:169], v233 offset:0
    v_mfma_f32_16x16x32_bf16 v[36:39], a[24:27], v[188:191], v[36:39]
    s_waitcnt lgkmcnt(11)
    ds_read_b64_tr_b16 v[170:171], v233 offset:4096
    ds_read_b64_tr_b16 v[188:189], v218 offset:24576
    v_mfma_f32_16x16x32_bf16 v[36:39], a[28:31], v[204:207], v[36:39]
    ds_read_b64_tr_b16 v[190:191], v218 offset:28672
    ds_read_b64_tr_b16 v[204:205], v218 offset:16384
    v_mfma_f32_16x16x32_bf16 v[68:71], a[16:19], v[172:175], 0
    ds_read_b64_tr_b16 v[172:173], v217 offset:16384
    ds_read_b64_tr_b16 v[174:175], v217 offset:20480
    v_mfma_f32_16x16x32_bf16 v[68:71], a[20:23], v[176:179], v[68:71]
    ds_read_b64_tr_b16 v[176:177], v217 offset:32768
    ds_read_b64_tr_b16 v[178:179], v217 offset:36864
    v_mfma_f32_16x16x32_bf16 v[68:71], a[24:27], v[192:195], v[68:71]
    ds_read_b64_tr_b16 v[192:193], v226 offset:57344
    ds_read_b64_tr_b16 v[194:195], v226 offset:61440
    v_mfma_f32_16x16x32_bf16 v[68:71], a[28:31], v[208:211], v[68:71]
    s_add_u32 s76, s98, 0
    ds_read_b64_tr_b16 v[206:207], v218 offset:20480
    ds_read_b64_tr_b16 v[208:209], v218 offset:32768
    v_mfma_f32_16x16x32_bf16 v[100:103], a[16:19], v[180:183], 0
    s_add_u32 s77, s99, 0
    ds_read_b64_tr_b16 v[180:181], v218 offset:40960
    ds_read_b64_tr_b16 v[182:183], v218 offset:45056
    v_mfma_f32_16x16x32_bf16 v[100:103], a[20:23], v[184:187], v[100:103]
    ds_read_b64_tr_b16 v[184:185], v226 offset:49152
    ds_read_b64_tr_b16 v[186:187], v226 offset:53248
    v_mfma_f32_16x16x32_bf16 v[100:103], a[24:27], v[196:199], v[100:103]
    s_add_u32 s78, s97, 4096
    buffer_load_dwordx4 a[112:115], v248, s[44:47], s76 offen sc1
    buffer_load_dwordx4 a[116:119], v248, s[44:47], s76 offen offset:1024 sc1
    buffer_load_dwordx4 a[120:123], v248, s[44:47], s76 offen offset:2048 sc1
    buffer_load_dwordx4 a[124:127], v248, s[44:47], s76 offen offset:3072 sc1
    buffer_load_dwordx4 a[160:163], v248, s[44:47], s77 offen sc1
    buffer_load_dwordx4 a[164:167], v248, s[44:47], s77 offen offset:1024 sc1
    buffer_load_dwordx4 a[168:171], v248, s[44:47], s77 offen offset:2048 sc1
    buffer_load_dwordx4 a[172:175], v248, s[44:47], s77 offen offset:3072 sc1
    v_mfma_f32_16x16x32_bf16 v[100:103], a[28:31], v[200:203], v[100:103]
    ds_read_b64_tr_b16 v[196:197], v218 offset:0
    ds_read_b64_tr_b16 v[198:199], v218 offset:4096
    s_waitcnt vmcnt(11)
    v_mfma_f32_16x16x32_bf16 v[12:15], a[224:227], a[64:67], v[12:15]
    s_waitcnt vmcnt(10)
    ds_read_b64_tr_b16 v[200:201], v234 offset:0
    ds_read_b64_tr_b16 v[202:203], v234 offset:4096
    v_mfma_f32_16x16x32_bf16 v[12:15], a[228:231], a[68:71], v[12:15]
    s_waitcnt vmcnt(9)
    buffer_load_dwordx4 a[80:83], v248, s[44:47], s78 offen sc1
    ds_read_b64_tr_b16 v[210:211], v218 offset:36864
    v_mfma_f32_16x16x32_bf16 v[12:15], a[232:235], a[72:75], v[12:15]
    s_waitcnt vmcnt(9)
    ds_read_b64_tr_b16 a[32:33], v219 offset:40960
    ds_read_b64_tr_b16 a[34:35], v219 offset:45056
    v_mfma_f32_16x16x32_bf16 v[12:15], a[236:239], a[76:79], v[12:15]
    ds_read_b64_tr_b16 a[36:37], v227 offset:49152
    ds_read_b64_tr_b16 a[38:39], v227 offset:53248
    v_mfma_f32_16x16x32_bf16 v[16:19], a[240:243], a[64:67], v[16:19]
    ds_read_b64_tr_b16 a[40:41], v219 offset:24576
    ds_read_b64_tr_b16 a[42:43], v219 offset:28672
    v_mfma_f32_16x16x32_bf16 v[16:19], a[244:247], a[68:71], v[16:19]
    buffer_load_dwordx4 a[84:87], v248, s[44:47], s78 offen offset:1024 sc1
    ds_read_b64_tr_b16 a[44:45], v227 offset:57344
    v_mfma_f32_16x16x32_bf16 v[16:19], a[248:251], a[72:75], v[16:19]
    ds_read_b64_tr_b16 a[46:47], v227 offset:61440
    ds_read_b64_tr_b16 a[16:17], v219 offset:0
    v_mfma_f32_16x16x32_bf16 v[16:19], a[252:255], a[76:79], v[16:19]
    ds_read_b64_tr_b16 a[18:19], v219 offset:4096
    ds_read_b64_tr_b16 a[20:21], v235 offset:0
    v_mfma_f32_16x16x32_bf16 v[20:23], v[116:119], a[64:67], v[20:23]
    ds_read_b64_tr_b16 a[22:23], v235 offset:4096
    ds_read_b64_tr_b16 a[24:25], v219 offset:16384
    v_mfma_f32_16x16x32_bf16 v[20:23], v[120:123], a[68:71], v[20:23]
    buffer_load_dwordx4 a[88:91], v248, s[44:47], s78 offen offset:2048 sc1
    ds_read_b64_tr_b16 a[26:27], v219 offset:20480
    v_mfma_f32_16x16x32_bf16 v[20:23], v[124:127], a[72:75], v[20:23]
    ds_read_b64_tr_b16 a[28:29], v219 offset:32768
    ds_read_b64_tr_b16 a[30:31], v219 offset:36864
    v_mfma_f32_16x16x32_bf16 v[20:23], v[128:131], a[76:79], v[20:23]
    v_mfma_f32_16x16x32_bf16 v[24:27], v[132:135], a[64:67], v[24:27]
    v_mfma_f32_16x16x32_bf16 v[24:27], v[136:139], a[68:71], v[24:27]
    buffer_load_dwordx4 a[92:95], v248, s[44:47], s78 offen offset:3072 sc1
    v_mfma_f32_16x16x32_bf16 v[24:27], v[140:143], a[72:75], v[24:27]
    s_add_u32 s79, s98, 4096
    v_mfma_f32_16x16x32_bf16 v[24:27], v[144:147], a[76:79], v[24:27]
    v_mfma_f32_16x16x32_bf16 v[28:31], v[148:151], a[64:67], v[28:31]
    v_mfma_f32_16x16x32_bf16 v[28:31], v[152:155], a[68:71], v[28:31]
    buffer_load_dwordx4 a[128:131], v248, s[44:47], s79 offen sc1
    v_mfma_f32_16x16x32_bf16 v[28:31], v[156:159], a[72:75], v[28:31]
    v_mfma_f32_16x16x32_bf16 v[28:31], v[160:163], a[76:79], v[28:31]
    v_mfma_f32_16x16x32_bf16 v[32:35], v[104:107], a[64:67], v[32:35]
    v_mfma_f32_16x16x32_bf16 v[32:35], v[108:111], a[68:71], v[32:35]
    buffer_load_dwordx4 a[132:135], v248, s[44:47], s79 offen offset:1024 sc1
    v_mfma_f32_16x16x32_bf16 v[32:35], v[112:115], a[72:75], v[32:35]
    v_mfma_f32_16x16x32_bf16 v[32:35], v[212:215], a[76:79], v[32:35]
    v_mfma_f32_16x16x32_bf16 v[36:39], a[48:51], a[64:67], v[36:39]
    v_mfma_f32_16x16x32_bf16 v[36:39], a[52:55], a[68:71], v[36:39]
    buffer_load_dwordx4 a[136:139], v248, s[44:47], s79 offen offset:2048 sc1
    v_mfma_f32_16x16x32_bf16 v[36:39], a[56:59], a[72:75], v[36:39]
    v_mfma_f32_16x16x32_bf16 v[36:39], a[60:63], a[76:79], v[36:39]
    s_waitcnt vmcnt(14) lgkmcnt(0)
    v_mfma_f32_16x16x32_bf16 v[12:15], a[0:3], a[112:115], v[12:15]
    s_waitcnt vmcnt(13)
    v_mfma_f32_16x16x32_bf16 v[12:15], a[4:7], a[116:119], v[12:15]
    s_waitcnt vmcnt(12)
    buffer_load_dwordx4 a[140:143], v248, s[44:47], s79 offen offset:3072 sc1
    v_mfma_f32_16x16x32_bf16 v[12:15], a[8:11], a[120:123], v[12:15]
    s_waitcnt vmcnt(12)
    s_add_u32 s76, s99, 4096
    v_mfma_f32_16x16x32_bf16 v[12:15], a[12:15], a[124:127], v[12:15]
    s_waitcnt vmcnt(11)
    v_mfma_f32_16x16x32_bf16 v[12:15], v[164:167], a[160:163], v[12:15]
    s_waitcnt vmcnt(10)
    v_mfma_f32_16x16x32_bf16 v[12:15], v[168:171], a[164:167], v[12:15]
    s_waitcnt vmcnt(9)
    buffer_load_dwordx4 a[176:179], v248, s[44:47], s76 offen sc1
    v_mfma_f32_16x16x32_bf16 v[12:15], v[172:175], a[168:171], v[12:15]
    s_waitcnt vmcnt(9)
    v_mfma_f32_16x16x32_bf16 v[12:15], v[176:179], a[172:175], v[12:15]
    v_mfma_f32_16x16x32_bf16 v[16:19], v[180:183], a[112:115], v[16:19]
    v_mfma_f32_16x16x32_bf16 v[16:19], v[184:187], a[116:119], v[16:19]
    buffer_load_dwordx4 a[180:183], v248, s[44:47], s76 offen offset:1024 sc1
    v_mfma_f32_16x16x32_bf16 v[16:19], v[188:191], a[120:123], v[16:19]
    v_mfma_f32_16x16x32_bf16 v[16:19], v[192:195], a[124:127], v[16:19]
    v_mfma_f32_16x16x32_bf16 v[16:19], v[196:199], a[160:163], v[16:19]
    v_mfma_f32_16x16x32_bf16 v[16:19], v[200:203], a[164:167], v[16:19]
    buffer_load_dwordx4 a[184:187], v248, s[44:47], s76 offen offset:2048 sc1
    v_mfma_f32_16x16x32_bf16 v[16:19], v[204:207], a[168:171], v[16:19]
    v_cvt_pk_bf16_f32 v12, v12, v13
    v_mfma_f32_16x16x32_bf16 v[16:19], v[208:211], a[172:175], v[16:19]
    v_cvt_pk_bf16_f32 v13, v14, v15
    v_mfma_f32_16x16x32_bf16 v[20:23], a[32:35], a[112:115], v[20:23]
    v_mfma_f32_16x16x32_bf16 v[20:23], a[36:39], a[116:119], v[20:23]
    buffer_load_dwordx4 a[188:191], v248, s[44:47], s76 offen offset:3072 sc1
    v_mfma_f32_16x16x32_bf16 v[20:23], a[40:43], a[120:123], v[20:23]
    s_add_u32 s77, s97, 8192
    v_mfma_f32_16x16x32_bf16 v[20:23], a[44:47], a[124:127], v[20:23]
    v_mfma_f32_16x16x32_bf16 v[20:23], a[16:19], a[160:163], v[20:23]
    v_mfma_f32_16x16x32_bf16 v[20:23], a[20:23], a[164:167], v[20:23]
    buffer_load_dwordx4 a[96:99], v248, s[44:47], s77 offen sc1
    v_mfma_f32_16x16x32_bf16 v[20:23], a[24:27], a[168:171], v[20:23]
    v_cvt_pk_bf16_f32 v16, v16, v17
    v_mfma_f32_16x16x32_bf16 v[20:23], a[28:31], a[172:175], v[20:23]
    s_waitcnt vmcnt(12)
    v_cvt_pk_bf16_f32 v17, v18, v19
    v_mfma_f32_16x16x32_bf16 v[44:47], a[224:227], a[80:83], v[44:47]
    s_waitcnt vmcnt(11)
    v_mfma_f32_16x16x32_bf16 v[44:47], a[228:231], a[84:87], v[44:47]
    s_waitcnt vmcnt(10)
    buffer_load_dwordx4 a[100:103], v248, s[44:47], s77 offen offset:1024 sc1
    v_mfma_f32_16x16x32_bf16 v[44:47], a[232:235], a[88:91], v[44:47]
    s_waitcnt vmcnt(10)
    v_mfma_f32_16x16x32_bf16 v[44:47], a[236:239], a[92:95], v[44:47]
    v_mfma_f32_16x16x32_bf16 v[48:51], a[240:243], a[80:83], v[48:51]
    v_mfma_f32_16x16x32_bf16 v[48:51], a[244:247], a[84:87], v[48:51]
    buffer_load_dwordx4 a[104:107], v248, s[44:47], s77 offen offset:2048 sc1
    v_mfma_f32_16x16x32_bf16 v[48:51], a[248:251], a[88:91], v[48:51]
    v_cvt_pk_bf16_f32 v20, v20, v21
    v_mfma_f32_16x16x32_bf16 v[48:51], a[252:255], a[92:95], v[48:51]
    v_cvt_pk_bf16_f32 v21, v22, v23
    v_mfma_f32_16x16x32_bf16 v[52:55], v[116:119], a[80:83], v[52:55]
    v_mfma_f32_16x16x32_bf16 v[52:55], v[120:123], a[84:87], v[52:55]
    buffer_load_dwordx4 a[108:111], v248, s[44:47], s77 offen offset:3072 sc1
    v_mfma_f32_16x16x32_bf16 v[52:55], v[124:127], a[88:91], v[52:55]
    s_add_u32 s78, s98, 8192
    v_mfma_f32_16x16x32_bf16 v[52:55], v[128:131], a[92:95], v[52:55]
    v_mfma_f32_16x16x32_bf16 v[56:59], v[132:135], a[80:83], v[56:59]
    v_mfma_f32_16x16x32_bf16 v[56:59], v[136:139], a[84:87], v[56:59]
    buffer_load_dwordx4 a[144:147], v248, s[44:47], s78 offen sc1
    v_mfma_f32_16x16x32_bf16 v[56:59], v[140:143], a[88:91], v[56:59]
    v_mfma_f32_16x16x32_bf16 v[56:59], v[144:147], a[92:95], v[56:59]
    v_mfma_f32_16x16x32_bf16 v[60:63], v[148:151], a[80:83], v[60:63]
    v_mfma_f32_16x16x32_bf16 v[60:63], v[152:155], a[84:87], v[60:63]
    buffer_load_dwordx4 a[148:151], v248, s[44:47], s78 offen offset:1024 sc1
    v_mfma_f32_16x16x32_bf16 v[60:63], v[156:159], a[88:91], v[60:63]
    v_mfma_f32_16x16x32_bf16 v[60:63], v[160:163], a[92:95], v[60:63]
    v_mfma_f32_16x16x32_bf16 v[64:67], v[104:107], a[80:83], v[64:67]
    v_mfma_f32_16x16x32_bf16 v[64:67], v[108:111], a[84:87], v[64:67]
    buffer_load_dwordx4 a[152:155], v248, s[44:47], s78 offen offset:2048 sc1
    v_mfma_f32_16x16x32_bf16 v[64:67], v[112:115], a[88:91], v[64:67]
    v_mfma_f32_16x16x32_bf16 v[64:67], v[212:215], a[92:95], v[64:67]
    v_mfma_f32_16x16x32_bf16 v[68:71], a[48:51], a[80:83], v[68:71]
    v_mfma_f32_16x16x32_bf16 v[68:71], a[52:55], a[84:87], v[68:71]
    buffer_load_dwordx4 a[156:159], v248, s[44:47], s78 offen offset:3072 sc1
    v_mfma_f32_16x16x32_bf16 v[68:71], a[56:59], a[88:91], v[68:71]
    s_add_u32 s79, s99, 8192
    v_mfma_f32_16x16x32_bf16 v[68:71], a[60:63], a[92:95], v[68:71]
    s_waitcnt vmcnt(15)
    v_mfma_f32_16x16x32_bf16 v[44:47], a[0:3], a[128:131], v[44:47]
    s_waitcnt vmcnt(14)
    v_mfma_f32_16x16x32_bf16 v[44:47], a[4:7], a[132:135], v[44:47]
    s_waitcnt vmcnt(13)
    buffer_load_dwordx4 a[192:195], v248, s[44:47], s79 offen sc1
    v_mfma_f32_16x16x32_bf16 v[44:47], a[8:11], a[136:139], v[44:47]
    s_waitcnt vmcnt(13)
    v_mfma_f32_16x16x32_bf16 v[44:47], a[12:15], a[140:143], v[44:47]
    s_waitcnt vmcnt(12)
    v_mfma_f32_16x16x32_bf16 v[44:47], v[164:167], a[176:179], v[44:47]
    s_waitcnt vmcnt(11)
    v_mfma_f32_16x16x32_bf16 v[44:47], v[168:171], a[180:183], v[44:47]
    s_waitcnt vmcnt(10)
    buffer_load_dwordx4 a[196:199], v248, s[44:47], s79 offen offset:1024 sc1
    v_mfma_f32_16x16x32_bf16 v[44:47], v[172:175], a[184:187], v[44:47]
    s_waitcnt vmcnt(10)
    v_mfma_f32_16x16x32_bf16 v[44:47], v[176:179], a[188:191], v[44:47]
    v_mfma_f32_16x16x32_bf16 v[48:51], v[180:183], a[128:131], v[48:51]
    v_mfma_f32_16x16x32_bf16 v[48:51], v[184:187], a[132:135], v[48:51]
    buffer_load_dwordx4 a[200:203], v248, s[44:47], s79 offen offset:2048 sc1
    v_mfma_f32_16x16x32_bf16 v[48:51], v[188:191], a[136:139], v[48:51]
    v_mfma_f32_16x16x32_bf16 v[48:51], v[192:195], a[140:143], v[48:51]
    v_mfma_f32_16x16x32_bf16 v[48:51], v[196:199], a[176:179], v[48:51]
    v_mfma_f32_16x16x32_bf16 v[48:51], v[200:203], a[180:183], v[48:51]
    buffer_load_dwordx4 a[204:207], v248, s[44:47], s79 offen offset:3072 sc1
    v_mfma_f32_16x16x32_bf16 v[48:51], v[204:207], a[184:187], v[48:51]
    v_cvt_pk_bf16_f32 v14, v44, v45
    v_mfma_f32_16x16x32_bf16 v[48:51], v[208:211], a[188:191], v[48:51]
    v_cvt_pk_bf16_f32 v15, v46, v47
    v_mfma_f32_16x16x32_bf16 v[52:55], a[32:35], a[128:131], v[52:55]
    buffer_store_dwordx4 v[12:15], v248, s[44:47], s56 offen sc1
    v_mfma_f32_16x16x32_bf16 v[52:55], a[36:39], a[132:135], v[52:55]
    v_mfma_f32_16x16x32_bf16 v[52:55], a[40:43], a[136:139], v[52:55]
    v_mfma_f32_16x16x32_bf16 v[52:55], a[44:47], a[140:143], v[52:55]
    v_mfma_f32_16x16x32_bf16 v[52:55], a[16:19], a[176:179], v[52:55]
L_pg7:
    s_cbranch_execz L_warmed
    v_mfma_f32_16x16x32_bf16 v[52:55], a[20:23], a[180:183], v[52:55]
    v_mfma_f32_16x16x32_bf16 v[52:55], a[24:27], a[184:187], v[52:55]
    v_cvt_pk_bf16_f32 v18, v48, v49
    v_mfma_f32_16x16x32_bf16 v[52:55], a[28:31], a[188:191], v[52:55]
    s_waitcnt vmcnt(12)
    v_cvt_pk_bf16_f32 v19, v50, v51
    v_mfma_f32_16x16x32_bf16 v[76:79], a[224:227], a[96:99], v[76:79]
    s_waitcnt vmcnt(11)
    buffer_store_dwordx4 v[16:19], v248, s[44:47], s57 offen sc1
    v_mfma_f32_16x16x32_bf16 v[76:79], a[228:231], a[100:103], v[76:79]
    s_waitcnt vmcnt(11)
    ds_read_b64_tr_b16 a[224:225], v220 offset:40960
    v_mfma_f32_16x16x32_bf16 v[76:79], a[232:235], a[104:107], v[76:79]
    s_waitcnt vmcnt(10)
    ds_read_b64_tr_b16 a[226:227], v220 offset:45056
    v_mfma_f32_16x16x32_bf16 v[76:79], a[236:239], a[108:111], v[76:79]
    ds_read_b64_tr_b16 a[228:229], v228 offset:49152
    v_mfma_f32_16x16x32_bf16 v[80:83], a[240:243], a[96:99], v[80:83]
    ds_read_b64_tr_b16 a[230:231], v228 offset:53248
    v_mfma_f32_16x16x32_bf16 v[80:83], a[244:247], a[100:103], v[80:83]
    ds_read_b64_tr_b16 a[232:233], v220 offset:24576
    v_mfma_f32_16x16x32_bf16 v[80:83], a[248:251], a[104:107], v[80:83]
    ds_read_b64_tr_b16 a[234:235], v220 offset:28672
    v_cvt_pk_bf16_f32 v22, v52, v53
    v_mfma_f32_16x16x32_bf16 v[80:83], a[252:255], a[108:111], v[80:83]
    ds_read_b64_tr_b16 a[236:237], v228 offset:57344
    v_cvt_pk_bf16_f32 v23, v54, v55
    v_mfma_f32_16x16x32_bf16 v[84:87], v[116:119], a[96:99], v[84:87]
    buffer_store_dwordx4 v[20:23], v248, s[44:47], s58 offen sc1
    v_mfma_f32_16x16x32_bf16 v[84:87], v[120:123], a[100:103], v[84:87]
    ds_read_b64_tr_b16 a[238:239], v228 offset:61440
    v_mfma_f32_16x16x32_bf16 v[84:87], v[124:127], a[104:107], v[84:87]
    ds_read_b64_tr_b16 a[240:241], v220 offset:0
    v_mfma_f32_16x16x32_bf16 v[84:87], v[128:131], a[108:111], v[84:87]
    ds_read_b64_tr_b16 a[242:243], v220 offset:4096
    v_mfma_f32_16x16x32_bf16 v[88:91], v[132:135], a[96:99], v[88:91]
    ds_read_b64_tr_b16 a[244:245], v236 offset:0
    v_mfma_f32_16x16x32_bf16 v[88:91], v[136:139], a[100:103], v[88:91]
    ds_read_b64_tr_b16 a[246:247], v236 offset:4096
    v_mfma_f32_16x16x32_bf16 v[88:91], v[140:143], a[104:107], v[88:91]
    ds_read_b64_tr_b16 a[248:249], v220 offset:16384
    v_mfma_f32_16x16x32_bf16 v[88:91], v[144:147], a[108:111], v[88:91]
    ds_read_b64_tr_b16 a[250:251], v220 offset:20480
    v_mfma_f32_16x16x32_bf16 v[92:95], v[148:151], a[96:99], v[92:95]
    ds_read_b64_tr_b16 a[252:253], v220 offset:32768
    v_mfma_f32_16x16x32_bf16 v[92:95], v[152:155], a[100:103], v[92:95]
    ds_read_b64_tr_b16 a[254:255], v220 offset:36864
    v_mfma_f32_16x16x32_bf16 v[92:95], v[156:159], a[104:107], v[92:95]
    ds_read_b64_tr_b16 v[116:117], v221 offset:40960
    v_mfma_f32_16x16x32_bf16 v[92:95], v[160:163], a[108:111], v[92:95]
    ds_read_b64_tr_b16 v[118:119], v221 offset:45056
    v_mfma_f32_16x16x32_bf16 v[96:99], v[104:107], a[96:99], v[96:99]
    ds_read_b64_tr_b16 v[120:121], v229 offset:49152
    v_mfma_f32_16x16x32_bf16 v[96:99], v[108:111], a[100:103], v[96:99]
    ds_read_b64_tr_b16 v[122:123], v229 offset:53248
    v_mfma_f32_16x16x32_bf16 v[96:99], v[112:115], a[104:107], v[96:99]
    ds_read_b64_tr_b16 v[124:125], v221 offset:24576
    v_mfma_f32_16x16x32_bf16 v[96:99], v[212:215], a[108:111], v[96:99]
    ds_read_b64_tr_b16 v[126:127], v221 offset:28672
    v_mfma_f32_16x16x32_bf16 v[100:103], a[48:51], a[96:99], v[100:103]
    ds_read_b64_tr_b16 v[128:129], v229 offset:57344
    v_mfma_f32_16x16x32_bf16 v[100:103], a[52:55], a[100:103], v[100:103]
    ds_read_b64_tr_b16 v[130:131], v229 offset:61440
    v_mfma_f32_16x16x32_bf16 v[100:103], a[56:59], a[104:107], v[100:103]
    ds_read_b64_tr_b16 v[132:133], v221 offset:0
    v_mfma_f32_16x16x32_bf16 v[100:103], a[60:63], a[108:111], v[100:103]
    s_waitcnt vmcnt(10)
    ds_read_b64_tr_b16 v[134:135], v221 offset:4096
    v_mfma_f32_16x16x32_bf16 v[76:79], a[0:3], a[144:147], v[76:79]
    s_waitcnt vmcnt(9)
    ds_read_b64_tr_b16 v[136:137], v237 offset:0
    v_mfma_f32_16x16x32_bf16 v[76:79], a[4:7], a[148:151], v[76:79]
    s_waitcnt vmcnt(8)
    ds_read_b64_tr_b16 v[138:139], v237 offset:4096
    v_mfma_f32_16x16x32_bf16 v[76:79], a[8:11], a[152:155], v[76:79]
    s_waitcnt vmcnt(7)
    ds_read_b64_tr_b16 v[140:141], v221 offset:16384
    v_mfma_f32_16x16x32_bf16 v[76:79], a[12:15], a[156:159], v[76:79]
    s_waitcnt vmcnt(6)
    ds_read_b64_tr_b16 v[142:143], v221 offset:20480
    v_mfma_f32_16x16x32_bf16 v[76:79], v[164:167], a[192:195], v[76:79]
    s_waitcnt vmcnt(5)
    ds_read_b64_tr_b16 v[144:145], v221 offset:32768
    v_mfma_f32_16x16x32_bf16 v[76:79], v[168:171], a[196:199], v[76:79]
    s_waitcnt vmcnt(4)
    ds_read_b64_tr_b16 v[146:147], v221 offset:36864
    v_mfma_f32_16x16x32_bf16 v[76:79], v[172:175], a[200:203], v[76:79]
    s_waitcnt vmcnt(3)
    ds_read_b64_tr_b16 v[148:149], v222 offset:40960
    v_mfma_f32_16x16x32_bf16 v[76:79], v[176:179], a[204:207], v[76:79]
    ds_read_b64_tr_b16 v[150:151], v222 offset:45056
    v_mfma_f32_16x16x32_bf16 v[80:83], v[180:183], a[144:147], v[80:83]
    ds_read_b64_tr_b16 v[152:153], v230 offset:49152
    v_mfma_f32_16x16x32_bf16 v[80:83], v[184:187], a[148:151], v[80:83]
    ds_read_b64_tr_b16 v[154:155], v230 offset:53248
    v_mfma_f32_16x16x32_bf16 v[80:83], v[188:191], a[152:155], v[80:83]
    ds_read_b64_tr_b16 v[156:157], v222 offset:24576
    v_mfma_f32_16x16x32_bf16 v[80:83], v[192:195], a[156:159], v[80:83]
    ds_read_b64_tr_b16 v[158:159], v222 offset:28672
    v_mfma_f32_16x16x32_bf16 v[80:83], v[196:199], a[192:195], v[80:83]
    ds_read_b64_tr_b16 v[160:161], v230 offset:57344
    v_mfma_f32_16x16x32_bf16 v[80:83], v[200:203], a[196:199], v[80:83]
    ds_read_b64_tr_b16 v[162:163], v230 offset:61440
    v_mfma_f32_16x16x32_bf16 v[80:83], v[204:207], a[200:203], v[80:83]
    ds_read_b64_tr_b16 v[104:105], v222 offset:0
    v_cvt_pk_bf16_f32 v76, v76, v77
    v_mfma_f32_16x16x32_bf16 v[80:83], v[208:211], a[204:207], v[80:83]
    ds_read_b64_tr_b16 v[106:107], v222 offset:4096
    v_cvt_pk_bf16_f32 v77, v78, v79
    v_mfma_f32_16x16x32_bf16 v[84:87], a[32:35], a[144:147], v[84:87]
    buffer_store_dwordx2 v[76:77], v241, s[44:47], s56 offen offset:1024 sc1
    v_mfma_f32_16x16x32_bf16 v[84:87], a[36:39], a[148:151], v[84:87]
    ds_read_b64_tr_b16 v[108:109], v238 offset:0
    v_mfma_f32_16x16x32_bf16 v[84:87], a[40:43], a[152:155], v[84:87]
    ds_read_b64_tr_b16 v[110:111], v238 offset:4096
    v_mfma_f32_16x16x32_bf16 v[84:87], a[44:47], a[156:159], v[84:87]
    ds_read_b64_tr_b16 v[112:113], v222 offset:16384
    v_mfma_f32_16x16x32_bf16 v[84:87], a[16:19], a[192:195], v[84:87]
    ds_read_b64_tr_b16 v[114:115], v222 offset:20480
    v_mfma_f32_16x16x32_bf16 v[84:87], a[20:23], a[196:199], v[84:87]
    ds_read_b64_tr_b16 v[212:213], v222 offset:32768
    v_mfma_f32_16x16x32_bf16 v[84:87], a[24:27], a[200:203], v[84:87]
    ds_read_b64_tr_b16 v[214:215], v222 offset:36864
    v_cvt_pk_bf16_f32 v80, v80, v81
    v_mfma_f32_16x16x32_bf16 v[84:87], a[28:31], a[204:207], v[84:87]
    ds_read_b64_tr_b16 a[48:49], v223 offset:40960
    v_cvt_pk_bf16_f32 v81, v82, v83
    s_waitcnt lgkmcnt(8)
    v_mfma_f32_16x16x32_bf16 v[24:27], a[224:227], a[112:115], v[24:27]
    buffer_store_dwordx2 v[80:81], v241, s[44:47], s57 offen offset:1024 sc1
    v_mfma_f32_16x16x32_bf16 v[24:27], a[228:231], a[116:119], v[24:27]
    ds_read_b64_tr_b16 a[50:51], v223 offset:45056
    v_mfma_f32_16x16x32_bf16 v[24:27], a[232:235], a[120:123], v[24:27]
    ds_read_b64_tr_b16 a[52:53], v231 offset:49152
    v_mfma_f32_16x16x32_bf16 v[24:27], a[236:239], a[124:127], v[24:27]
    ds_read_b64_tr_b16 a[54:55], v231 offset:53248
    v_mfma_f32_16x16x32_bf16 v[24:27], a[240:243], a[160:163], v[24:27]
    ds_read_b64_tr_b16 a[56:57], v223 offset:24576
    v_mfma_f32_16x16x32_bf16 v[24:27], a[244:247], a[164:167], v[24:27]
    ds_read_b64_tr_b16 a[58:59], v223 offset:28672
    v_mfma_f32_16x16x32_bf16 v[24:27], a[248:251], a[168:171], v[24:27]
    ds_read_b64_tr_b16 a[60:61], v231 offset:57344
    v_cvt_pk_bf16_f32 v84, v84, v85
    v_mfma_f32_16x16x32_bf16 v[24:27], a[252:255], a[172:175], v[24:27]
    ds_read_b64_tr_b16 a[62:63], v231 offset:61440
    v_cvt_pk_bf16_f32 v85, v86, v87
    v_mfma_f32_16x16x32_bf16 v[56:59], a[224:227], a[128:131], v[56:59]
    buffer_store_dwordx2 v[84:85], v241, s[44:47], s58 offen offset:1024 sc1
    v_mfma_f32_16x16x32_bf16 v[56:59], a[228:231], a[132:135], v[56:59]
    v_mfma_f32_16x16x32_bf16 v[56:59], a[232:235], a[136:139], v[56:59]
    v_mfma_f32_16x16x32_bf16 v[56:59], a[236:239], a[140:143], v[56:59]
    v_mfma_f32_16x16x32_bf16 v[56:59], a[240:243], a[176:179], v[56:59]
    v_mfma_f32_16x16x32_bf16 v[56:59], a[244:247], a[180:183], v[56:59]
    v_mfma_f32_16x16x32_bf16 v[56:59], a[248:251], a[184:187], v[56:59]
    v_cvt_pk_bf16_f32 v24, v24, v25
    v_mfma_f32_16x16x32_bf16 v[56:59], a[252:255], a[188:191], v[56:59]
    v_cvt_pk_bf16_f32 v25, v26, v27
    v_mfma_f32_16x16x32_bf16 v[88:91], a[224:227], a[144:147], v[88:91]
    ds_read_b64_tr_b16 a[224:225], v223 offset:0
    v_mfma_f32_16x16x32_bf16 v[88:91], a[228:231], a[148:151], v[88:91]
    ds_read_b64_tr_b16 a[226:227], v223 offset:4096
    v_mfma_f32_16x16x32_bf16 v[88:91], a[232:235], a[152:155], v[88:91]
    ds_read_b64_tr_b16 a[228:229], v239 offset:0
    v_mfma_f32_16x16x32_bf16 v[88:91], a[236:239], a[156:159], v[88:91]
    ds_read_b64_tr_b16 a[230:231], v239 offset:4096
    v_mfma_f32_16x16x32_bf16 v[88:91], a[240:243], a[192:195], v[88:91]
    ds_read_b64_tr_b16 a[232:233], v223 offset:16384
    v_mfma_f32_16x16x32_bf16 v[88:91], a[244:247], a[196:199], v[88:91]
    ds_read_b64_tr_b16 a[234:235], v223 offset:20480
    v_mfma_f32_16x16x32_bf16 v[88:91], a[248:251], a[200:203], v[88:91]
    ds_read_b64_tr_b16 a[236:237], v223 offset:32768
    v_cvt_pk_bf16_f32 v26, v56, v57
    v_mfma_f32_16x16x32_bf16 v[88:91], a[252:255], a[204:207], v[88:91]
    ds_read_b64_tr_b16 a[238:239], v223 offset:36864
    v_cvt_pk_bf16_f32 v27, v58, v59
    v_mfma_f32_16x16x32_bf16 v[28:31], v[116:119], a[112:115], v[28:31]
    buffer_store_dwordx4 v[24:27], v248, s[44:47], s59 offen sc1
    v_mfma_f32_16x16x32_bf16 v[28:31], v[120:123], a[116:119], v[28:31]
    ds_read_b64_tr_b16 a[240:241], v216 offset:40960
    v_mfma_f32_16x16x32_bf16 v[28:31], v[124:127], a[120:123], v[28:31]
    ds_read_b64_tr_b16 a[242:243], v216 offset:45056
    v_mfma_f32_16x16x32_bf16 v[28:31], v[128:131], a[124:127], v[28:31]
    ds_read_b64_tr_b16 a[244:245], v224 offset:49152
    v_mfma_f32_16x16x32_bf16 v[28:31], v[132:135], a[160:163], v[28:31]
    ds_read_b64_tr_b16 a[246:247], v224 offset:53248
    v_mfma_f32_16x16x32_bf16 v[28:31], v[136:139], a[164:167], v[28:31]
    ds_read_b64_tr_b16 a[248:249], v216 offset:24576
    v_mfma_f32_16x16x32_bf16 v[28:31], v[140:143], a[168:171], v[28:31]
    ds_read_b64_tr_b16 a[250:251], v216 offset:28672
    v_cvt_pk_bf16_f32 v88, v88, v89
    v_mfma_f32_16x16x32_bf16 v[28:31], v[144:147], a[172:175], v[28:31]
    ds_read_b64_tr_b16 a[252:253], v224 offset:57344
    v_cvt_pk_bf16_f32 v89, v90, v91
    v_mfma_f32_16x16x32_bf16 v[60:63], v[116:119], a[128:131], v[60:63]
    buffer_store_dwordx2 v[88:89], v241, s[44:47], s59 offen offset:1024 sc1
    v_mfma_f32_16x16x32_bf16 v[60:63], v[120:123], a[132:135], v[60:63]
    ds_read_b64_tr_b16 a[254:255], v224 offset:61440
    v_mfma_f32_16x16x32_bf16 v[60:63], v[124:127], a[136:139], v[60:63]
    v_mfma_f32_16x16x32_bf16 v[60:63], v[128:131], a[140:143], v[60:63]
    v_mfma_f32_16x16x32_bf16 v[60:63], v[132:135], a[176:179], v[60:63]
    v_mfma_f32_16x16x32_bf16 v[60:63], v[136:139], a[180:183], v[60:63]
    v_mfma_f32_16x16x32_bf16 v[60:63], v[140:143], a[184:187], v[60:63]
    v_cvt_pk_bf16_f32 v28, v28, v29
    v_mfma_f32_16x16x32_bf16 v[60:63], v[144:147], a[188:191], v[60:63]
    v_cvt_pk_bf16_f32 v29, v30, v31
    v_mfma_f32_16x16x32_bf16 v[92:95], v[116:119], a[144:147], v[92:95]
    ds_read_b64_tr_b16 v[116:117], v216 offset:0
    v_mfma_f32_16x16x32_bf16 v[92:95], v[120:123], a[148:151], v[92:95]
    ds_read_b64_tr_b16 v[118:119], v216 offset:4096
    v_mfma_f32_16x16x32_bf16 v[92:95], v[124:127], a[152:155], v[92:95]
    ds_read_b64_tr_b16 v[120:121], v232 offset:0
    v_mfma_f32_16x16x32_bf16 v[92:95], v[128:131], a[156:159], v[92:95]
    ds_read_b64_tr_b16 v[122:123], v232 offset:4096
    v_mfma_f32_16x16x32_bf16 v[92:95], v[132:135], a[192:195], v[92:95]
    ds_read_b64_tr_b16 v[124:125], v216 offset:16384
    v_mfma_f32_16x16x32_bf16 v[92:95], v[136:139], a[196:199], v[92:95]
    ds_read_b64_tr_b16 v[126:127], v216 offset:20480
    v_mfma_f32_16x16x32_bf16 v[92:95], v[140:143], a[200:203], v[92:95]
    ds_read_b64_tr_b16 v[128:129], v216 offset:32768
    v_cvt_pk_bf16_f32 v30, v60, v61
    v_mfma_f32_16x16x32_bf16 v[92:95], v[144:147], a[204:207], v[92:95]
    ds_read_b64_tr_b16 v[130:131], v216 offset:36864
    v_cvt_pk_bf16_f32 v31, v62, v63
    v_mfma_f32_16x16x32_bf16 v[32:35], v[148:151], a[112:115], v[32:35]
    s_movk_i32 s83, 0x3f80
    buffer_store_dwordx4 v[28:31], v248, s[44:47], s60 offen sc1
    v_lshrrev_b32 v0, 4, v248
    v_mfma_f32_16x16x32_bf16 v[32:35], v[152:155], a[116:119], v[32:35]
    v_bfe_u32 v1, v0, 2, 2
    v_mfma_f32_16x16x32_bf16 v[32:35], v[156:159], a[120:123], v[32:35]
    v_lshrrev_b32 v2, 4, v0
    v_mfma_f32_16x16x32_bf16 v[32:35], v[160:163], a[124:127], v[32:35]
    s_waitcnt lgkmcnt(5)
    v_and_b32 v3, 1, v0
    v_mfma_f32_16x16x32_bf16 v[32:35], v[104:107], a[160:163], v[32:35]
    v_lshlrev_b32 v3, 4, v3
    v_mfma_f32_16x16x32_bf16 v[32:35], v[108:111], a[164:167], v[32:35]
    v_lshlrev_b32 v3, v3, s83
    v_mfma_f32_16x16x32_bf16 v[32:35], v[112:115], a[168:171], v[32:35]
    v_cvt_pk_bf16_f32 v92, v92, v93
    v_mfma_f32_16x16x32_bf16 v[32:35], v[212:215], a[172:175], v[32:35]
    v_cvt_pk_bf16_f32 v93, v94, v95
    v_mfma_f32_16x16x32_bf16 v[64:67], v[148:151], a[128:131], v[64:67]
    buffer_store_dwordx2 v[92:93], v241, s[44:47], s60 offen offset:1024 sc1
    v_cmp_eq_u32 vcc, v1, v2
    v_mfma_f32_16x16x32_bf16 v[64:67], v[152:155], a[132:135], v[64:67]
    s_nop 0
    v_cndmask_b32 v3, 0, v3, vcc
    v_mfma_f32_16x16x32_bf16 v[64:67], v[156:159], a[136:139], v[64:67]
    v_and_b32 v1, 2, v0
    v_mfma_f32_16x16x32_bf16 v[64:67], v[160:163], a[140:143], v[64:67]
    v_cmp_eq_u32 vcc, 0, v1
    v_mfma_f32_16x16x32_bf16 v[64:67], v[104:107], a[176:179], v[64:67]
    s_nop 0
    v_cndmask_b32 v2, 0, v3, vcc
    v_mfma_f32_16x16x32_bf16 v[64:67], v[108:111], a[180:183], v[64:67]
    v_sub_u32 v3, v3, v2
    v_mfma_f32_16x16x32_bf16 v[64:67], v[112:115], a[184:187], v[64:67]
    v_cvt_pk_bf16_f32 v32, v32, v33
    v_mfma_f32_16x16x32_bf16 v[64:67], v[212:215], a[188:191], v[64:67]
    v_cvt_pk_bf16_f32 v33, v34, v35
    v_mfma_f32_16x16x32_bf16 v[96:99], v[148:151], a[144:147], v[96:99]
    v_and_b32 v1, 7, v0
    v_mfma_f32_16x16x32_bf16 v[96:99], v[152:155], a[148:151], v[96:99]
    v_xor_b32 v1, s74, v1
    v_mfma_f32_16x16x32_bf16 v[96:99], v[156:159], a[152:155], v[96:99]
    v_lshl_add_u32 v1, v1, 2, s75
    v_mfma_f32_16x16x32_bf16 v[96:99], v[160:163], a[156:159], v[96:99]
    v_mul_u32_u24 v1, 4608, v1
    v_mfma_f32_16x16x32_bf16 v[96:99], v[104:107], a[192:195], v[96:99]
    v_cmp_lt_u32 vcc, 7, v0
    v_mfma_f32_16x16x32_bf16 v[96:99], v[108:111], a[196:199], v[96:99]
    s_nop 0
    v_cndmask_b32 v1, v1, v4, vcc
    v_mfma_f32_16x16x32_bf16 v[96:99], v[112:115], a[200:203], v[96:99]
    v_cvt_pk_bf16_f32 v34, v64, v65
    v_mfma_f32_16x16x32_bf16 v[96:99], v[212:215], a[204:207], v[96:99]
    v_cvt_pk_bf16_f32 v35, v66, v67
    v_mfma_f32_16x16x32_bf16 v[36:39], a[48:51], a[112:115], v[36:39]
    buffer_store_dwordx4 v[32:35], v248, s[44:47], s61 offen sc1
    v_mov_b32 v5, s0
    v_mfma_f32_16x16x32_bf16 v[36:39], a[52:55], a[116:119], v[36:39]
    v_mfma_f32_16x16x32_bf16 v[36:39], a[56:59], a[120:123], v[36:39]
    v_mfma_f32_16x16x32_bf16 v[36:39], a[60:63], a[124:127], v[36:39]
    v_mfma_f32_16x16x32_bf16 v[36:39], a[224:227], a[160:163], v[36:39]
    v_mfma_f32_16x16x32_bf16 v[36:39], a[228:231], a[164:167], v[36:39]
    v_mfma_f32_16x16x32_bf16 v[36:39], a[232:235], a[168:171], v[36:39]
    v_cvt_pk_bf16_f32 v96, v96, v97
    v_mfma_f32_16x16x32_bf16 v[36:39], a[236:239], a[172:175], v[36:39]
    v_cvt_pk_bf16_f32 v97, v98, v99
    v_mfma_f32_16x16x32_bf16 v[68:71], a[48:51], a[128:131], v[68:71]
    buffer_store_dwordx2 v[96:97], v241, s[44:47], s61 offen offset:1024 sc1
    v_mfma_f32_16x16x32_bf16 v[68:71], a[52:55], a[132:135], v[68:71]
    v_mfma_f32_16x16x32_bf16 v[68:71], a[56:59], a[136:139], v[68:71]
    v_mfma_f32_16x16x32_bf16 v[68:71], a[60:63], a[140:143], v[68:71]
    v_mfma_f32_16x16x32_bf16 v[68:71], a[224:227], a[176:179], v[68:71]
    v_mfma_f32_16x16x32_bf16 v[68:71], a[228:231], a[180:183], v[68:71]
    v_mfma_f32_16x16x32_bf16 v[68:71], a[232:235], a[184:187], v[68:71]
    v_cvt_pk_bf16_f32 v36, v36, v37
    v_mfma_f32_16x16x32_bf16 v[68:71], a[236:239], a[188:191], v[68:71]
    v_cvt_pk_bf16_f32 v37, v38, v39
    v_mfma_f32_16x16x32_bf16 v[100:103], a[48:51], a[144:147], v[100:103]
    v_mfma_f32_16x16x32_bf16 v[100:103], a[52:55], a[148:151], v[100:103]
    v_mfma_f32_16x16x32_bf16 v[100:103], a[56:59], a[152:155], v[100:103]
    v_mfma_f32_16x16x32_bf16 v[100:103], a[60:63], a[156:159], v[100:103]
    v_mfma_f32_16x16x32_bf16 v[100:103], a[224:227], a[192:195], v[100:103]
    v_mfma_f32_16x16x32_bf16 v[100:103], a[228:231], a[196:199], v[100:103]
    v_mfma_f32_16x16x32_bf16 v[100:103], a[232:235], a[200:203], v[100:103]
    v_cvt_pk_bf16_f32 v38, v68, v69
    v_mfma_f32_16x16x32_bf16 v[100:103], a[236:239], a[204:207], v[100:103]
    v_cvt_pk_bf16_f32 v39, v70, v71
    v_mfma_f32_16x16x32_bf16 v[8:11], a[208:211], a[64:67], v[8:11]
    buffer_store_dwordx4 v[36:39], v248, s[44:47], s62 offen sc1
    v_mfma_f32_16x16x32_bf16 v[8:11], a[212:215], a[68:71], v[8:11]
    v_mfma_f32_16x16x32_bf16 v[8:11], a[216:219], a[72:75], v[8:11]
    v_mfma_f32_16x16x32_bf16 v[8:11], a[220:223], a[76:79], v[8:11]
    v_mfma_f32_16x16x32_bf16 v[8:11], a[240:243], a[112:115], v[8:11]
    v_mfma_f32_16x16x32_bf16 v[8:11], a[244:247], a[116:119], v[8:11]
    v_mfma_f32_16x16x32_bf16 v[8:11], a[248:251], a[120:123], v[8:11]
    v_cvt_pk_bf16_f32 v100, v100, v101
    v_mfma_f32_16x16x32_bf16 v[8:11], a[252:255], a[124:127], v[8:11]
    v_cvt_pk_bf16_f32 v101, v102, v103
    v_mfma_f32_16x16x32_bf16 v[8:11], v[116:119], a[160:163], v[8:11]
    s_waitcnt lgkmcnt(0)
    buffer_store_dwordx2 v[100:101], v241, s[44:47], s62 offen offset:1024 sc1
    v_mfma_f32_16x16x32_bf16 v[8:11], v[120:123], a[164:167], v[8:11]
    v_mfma_f32_16x16x32_bf16 v[8:11], v[124:127], a[168:171], v[8:11]
    v_mfma_f32_16x16x32_bf16 v[8:11], v[128:131], a[172:175], v[8:11]
    v_mfma_f32_16x16x32_bf16 v[40:43], a[208:211], a[80:83], v[40:43]
    v_mfma_f32_16x16x32_bf16 v[40:43], a[212:215], a[84:87], v[40:43]
    v_mfma_f32_16x16x32_bf16 v[40:43], a[216:219], a[88:91], v[40:43]
    v_mfma_f32_16x16x32_bf16 v[40:43], a[220:223], a[92:95], v[40:43]
    v_mfma_f32_16x16x32_bf16 v[40:43], a[240:243], a[128:131], v[40:43]
    v_mfma_f32_16x16x32_bf16 v[40:43], a[244:247], a[132:135], v[40:43]
    v_mfma_f32_16x16x32_bf16 v[40:43], a[248:251], a[136:139], v[40:43]
    v_mfma_f32_16x16x32_bf16 v[40:43], a[252:255], a[140:143], v[40:43]
    v_mfma_f32_16x16x32_bf16 v[40:43], v[116:119], a[176:179], v[40:43]
    v_mfma_f32_16x16x32_bf16 v[40:43], v[120:123], a[180:183], v[40:43]
    v_mfma_f32_16x16x32_bf16 v[40:43], v[124:127], a[184:187], v[40:43]
    v_mfma_f32_16x16x32_bf16 v[40:43], v[128:131], a[188:191], v[40:43]
    v_mfma_f32_16x16x32_bf16 v[72:75], a[208:211], a[96:99], v[72:75]
    v_mfma_f32_16x16x32_bf16 v[72:75], a[212:215], a[100:103], v[72:75]
    v_mfma_f32_16x16x32_bf16 v[72:75], a[216:219], a[104:107], v[72:75]
    v_mfma_f32_16x16x32_bf16 v[72:75], a[220:223], a[108:111], v[72:75]
    v_mfma_f32_16x16x32_bf16 v[72:75], a[240:243], a[144:147], v[72:75]
    v_mfma_f32_16x16x32_bf16 v[72:75], a[244:247], a[148:151], v[72:75]
    v_mfma_f32_16x16x32_bf16 v[72:75], a[248:251], a[152:155], v[72:75]
    v_mfma_f32_16x16x32_bf16 v[72:75], a[252:255], a[156:159], v[72:75]
    v_mfma_f32_16x16x32_bf16 v[72:75], v[116:119], a[192:195], v[72:75]
    v_mfma_f32_16x16x32_bf16 v[72:75], v[120:123], a[196:199], v[72:75]
    v_mfma_f32_16x16x32_bf16 v[72:75], v[124:127], a[200:203], v[72:75]
    v_mfma_f32_16x16x32_bf16 v[72:75], v[128:131], a[204:207], v[72:75]
    v_mov_b32 v116, v2
    v_mov_b32 v117, v3
    v_mov_b32 v118, 0
    v_mov_b32 v119, 0
    v_mov_b32 v120, v2
    v_mov_b32 v121, v3
    v_mov_b32 v122, v2
    v_mov_b32 v123, v3
    v_mov_b32 v206, 0
    v_mov_b32 v207, 0
    v_mov_b32 v124, s80
    v_mov_b32 v125, s80
    v_mov_b32 v126, s80
    v_mov_b32 v127, s80
    s_mov_b32 s76, 0xffffff01
    s_mov_b32 s84, 0
    s_waitcnt vmcnt(0)
    s_mov_b64 exec, 0xff
    buffer_store_dwordx4 v[124:127], v248, s[44:47], s96 offen sc1
    s_mov_b64 exec, -1
L_look:
    v_cmp_eq_u32 vcc, s80, v5
    s_nop 3
    s_andn2_b32 s77, vcc_lo, s76
    s_or_b32 s76, s76, s77
    s_bitcmp1_b32 s77, 1
    s_cbranch_scc0 L_skip1
    s_add_u32 s79, s89, 0
    buffer_load_dwordx4 v[164:167], v248, s[44:47], s79 offen sc1
    buffer_load_dwordx2 v[192:193], v241, s[44:47], s79 offen offset:1024 sc1
L_skip1:
    s_bitcmp1_b32 s77, 2
    s_cbranch_scc0 L_skip2
    s_add_u32 s79, s89, 1536
    buffer_load_dwordx4 v[168:171], v248, s[44:47], s79 offen sc1
    buffer_load_dwordx2 v[194:195], v241, s[44:47], s79 offen offset:1024 sc1
L_skip2:
    s_bitcmp1_b32 s77, 3
    s_cbranch_scc0 L_skip3
    s_add_u32 s79, s89, 3072
    buffer_load_dwordx4 v[172:175], v248, s[44:47], s79 offen sc1
    buffer_load_dwordx2 v[196:197], v241, s[44:47], s79 offen offset:1024 sc1
L_skip3:
    s_bitcmp1_b32 s77, 4
    s_cbranch_scc0 L_skip4
    s_add_u32 s79, s89, 4608
    buffer_load_dwordx4 v[176:179], v248, s[44:47], s79 offen sc1
    buffer_load_dwordx2 v[198:199], v241, s[44:47], s79 offen offset:1024 sc1
L_skip4:
    s_bitcmp1_b32 s77, 5
    s_cbranch_scc0 L_skip5
    s_add_u32 s79, s89, 6144
    buffer_load_dwordx4 v[180:183], v248, s[44:47], s79 offen sc1
    buffer_load_dwordx2 v[200:201], v241, s[44:47], s79 offen offset:1024 sc1
L_skip5:
    s_bitcmp1_b32 s77, 6
    s_cbranch_scc0 L_skip6
    s_add_u32 s79, s89, 7680
    buffer_load_dwordx4 v[184:187], v248, s[44:47], s79 offen sc1
    buffer_load_dwordx2 v[202:203], v241, s[44:47], s79 offen offset:1024 sc1
L_skip6:
    s_bitcmp1_b32 s77, 7
    s_cbranch_scc0 L_skip7
    s_add_u32 s79, s89, 9216
    buffer_load_dwordx4 v[188:191], v248, s[44:47], s79 offen sc1
    buffer_load_dwordx2 v[204:205], v241, s[44:47], s79 offen offset:1024 sc1
L_skip7:
    s_and_b32 s77, s76, 0xff
    s_cmp_eq_u32 s77, 0xff
    s_cbranch_scc1 L_all
    v_mov_b32 v128, 0
    buffer_atomic_or v128, v1, s[44:47], s88 offen sc0 sc1
L_spin:
    s_waitcnt vmcnt(0)
    v_mov_b32 v5, v128
    v_cmp_eq_u32 vcc, s80, v128
    s_nop 3
    s_andn2_b32 s77, vcc_lo, s76
    s_cbranch_scc1 L_look
    v_mov_b32 v128, 0
    buffer_atomic_or v128, v1, s[44:47], s88 offen sc0 sc1
    s_add_u32 s84, s84, 1
    s_cmp_lt_u32 s84, 32768
    s_cbranch_scc1 L_spin
L_all:
    s_or_b32 s82, s21, s22
    s_cbranch_scc1 L_keep
    s_lshl_b32 s82, s20, 12
    s_add_u32 s82, s82, 41943040
    s_mov_b64 exec, 0xff
    buffer_store_dwordx4 v[124:127], v248, s[44:47], s82 offen sc1
    s_mov_b64 exec, -1
    s_waitcnt vmcnt(1)
    s_branch L_sum
L_keep:
    s_waitcnt vmcnt(0)
L_sum:
    v_mfma_f32_16x16x32_bf16 v[8:11], v[116:119], v[164:167], v[8:11]
    v_mfma_f32_16x16x32_bf16 v[8:11], v[116:119], v[168:171], v[8:11]
    v_mfma_f32_16x16x32_bf16 v[8:11], v[116:119], v[172:175], v[8:11]
    v_mfma_f32_16x16x32_bf16 v[8:11], v[116:119], v[176:179], v[8:11]
    v_mfma_f32_16x16x32_bf16 v[8:11], v[116:119], v[180:183], v[8:11]
    v_mfma_f32_16x16x32_bf16 v[8:11], v[116:119], v[184:187], v[8:11]
    v_mfma_f32_16x16x32_bf16 v[8:11], v[116:119], v[188:191], v[8:11]
    v_mfma_f32_16x16x32_bf16 v[40:43], v[118:121], v[164:167], v[40:43]
    v_mfma_f32_16x16x32_bf16 v[40:43], v[118:121], v[168:171], v[40:43]
    v_mfma_f32_16x16x32_bf16 v[40:43], v[118:121], v[172:175], v[40:43]
    v_mfma_f32_16x16x32_bf16 v[40:43], v[118:121], v[176:179], v[40:43]
    v_mfma_f32_16x16x32_bf16 v[40:43], v[118:121], v[180:183], v[40:43]
    v_mfma_f32_16x16x32_bf16 v[40:43], v[118:121], v[184:187], v[40:43]
    v_mfma_f32_16x16x32_bf16 v[40:43], v[118:121], v[188:191], v[40:43]
    v_mfma_f32_16x16x32_bf16 v[72:75], v[120:123], v[192:195], v[72:75]
    v_mfma_f32_16x16x32_bf16 v[72:75], v[120:123], v[196:199], v[72:75]
    v_mfma_f32_16x16x32_bf16 v[72:75], v[120:123], v[200:203], v[72:75]
    v_mfma_f32_16x16x32_bf16 v[72:75], v[120:123], v[204:207], v[72:75]
    v_cvt_pk_bf16_f32 v8, v8, v9
    v_cvt_pk_bf16_f32 v9, v10, v11
    s_mov_b32 s76, 0
    buffer_store_dwordx2 v[8:9], v251, s[48:51], s76 offen
    v_cvt_pk_bf16_f32 v40, v40, v41
    v_cvt_pk_bf16_f32 v41, v42, v43
    s_mov_b32 s76, 16384
    buffer_store_dwordx2 v[40:41], v251, s[48:51], s76 offen
    v_cvt_pk_bf16_f32 v72, v72, v73
    v_cvt_pk_bf16_f32 v73, v74, v75
    s_mov_b32 s76, 32768
    buffer_store_dwordx2 v[72:73], v251, s[48:51], s76 offen
L_end:
    s_endpgm
L_codeend:
L_far:
    s_mov_b64 exec, 1
    buffer_store_dword v6, v7, s[44:47], s1 offen sc1
    s_mov_b64 exec, -1
    s_branch L_farback
L_wait1:
    s_mov_b32 s84, 0
L_poll1:
    buffer_load_dword v5, v246, s[44:47], 0 offen sc1
    s_waitcnt vmcnt(0)
    v_cmp_ne_u32 vcc, s80, v5
    s_add_u32 s84, s84, 1
    s_nop 2
    s_cbranch_vccz L_seen1
    s_cmp_lt_u32 s84, 32768
    s_cbranch_scc1 L_poll1
L_seen1:
    s_branch L_go1
L_slow:
    s_waitcnt vmcnt(0) lgkmcnt(0)
    v_lshrrev_b32 v0, 4, v248
    v_lshrrev_b32 v1, 4, v0
    v_and_b32 v2, 15, v0
    v_and_b32 v3, 1, v1
    v_lshrrev_b32 v4, 1, v1
    v_lshl_add_u32 v3, v3, 1, v4
    v_lshlrev_b32 v3, 4, v3
    v_lshl_add_u32 v216, v2, 8, v3
    v_lshlrev_b32 v3, 1, v1
    v_xor_b32 v3, v3, v2
    v_lshlrev_b32 v3, 4, v3
    v_lshl_add_u32 v230, v1, 8, v3
    v_xor_b32 v231, 128, v230
    s_mov_b32 s77, 8192
    s_cmp_eq_u32 s22, 1
    s_cselect_b32 s77, 139264, s77
    s_cmp_eq_u32 s22, 2
    s_cselect_b32 s77, 147456, s77
    s_cmp_eq_u32 s22, 3
    s_cselect_b32 s77, 155648, s77
    s_sub_u32 s84, s77, 98304
    v_add_u32 v232, s84, v220
    v_add_u32 v233, s84, v221
    v_add_u32 v234, s84, v222
    v_add_u32 v235, s84, v223
    v_add_u32 v236, s84, v224
    v_add_u32 v237, s84, v225
    v_add_u32 v238, s84, v226
    v_add_u32 v239, s84, v227
    v_mov_b32 v0, 0xff800000
    v_mov_b32 v1, 0xff800000
    v_mov_b32 v2, 0xff800000
    s_mov_b32 s82, 0
L_s1:
    s_add_u32 s83, s82, 4096
    buffer_load_dwordx4 a[0:3], v216, s[32:35], s82 offen offset:0
    buffer_load_dwordx4 a[4:7], v216, s[32:35], s82 offen offset:64
    buffer_load_dwordx4 a[8:11], v216, s[32:35], s82 offen offset:128
    buffer_load_dwordx4 a[12:15], v216, s[32:35], s82 offen offset:192
    buffer_load_dwordx4 a[16:19], v216, s[32:35], s83 offen offset:0
    buffer_load_dwordx4 a[20:23], v216, s[32:35], s83 offen offset:64
    buffer_load_dwordx4 a[24:27], v216, s[32:35], s83 offen offset:128
    buffer_load_dwordx4 a[28:31], v216, s[32:35], s83 offen offset:192
    s_waitcnt vmcnt(7)
    v_mfma_f32_16x16x32_bf16 v[164:167], a[0:3], v[116:119], 0
    s_waitcnt vmcnt(6)
    v_mfma_f32_16x16x32_bf16 v[164:167], a[4:7], v[120:123], v[164:167]
    s_waitcnt vmcnt(5)
    v_mfma_f32_16x16x32_bf16 v[164:167], a[8:11], v[124:127], v[164:167]
    s_waitcnt vmcnt(4)
    v_mfma_f32_16x16x32_bf16 v[164:167], a[12:15], v[128:131], v[164:167]
    s_waitcnt vmcnt(3)
    v_mfma_f32_16x16x32_bf16 v[168:171], a[16:19], v[116:119], 0
    s_waitcnt vmcnt(2)
    v_mfma_f32_16x16x32_bf16 v[168:171], a[20:23], v[120:123], v[168:171]
    s_waitcnt vmcnt(1)
    v_mfma_f32_16x16x32_bf16 v[168:171], a[24:27], v[124:127], v[168:171]
    s_waitcnt vmcnt(0)
    v_mfma_f32_16x16x32_bf16 v[168:171], a[28:31], v[128:131], v[168:171]
    v_mfma_f32_16x16x32_bf16 v[172:175], a[0:3], v[132:135], 0
    v_mfma_f32_16x16x32_bf16 v[172:175], a[4:7], v[136:139], v[172:175]
    v_mfma_f32_16x16x32_bf16 v[172:175], a[8:11], v[140:143], v[172:175]
    v_mfma_f32_16x16x32_bf16 v[172:175], a[12:15], v[144:147], v[172:175]
    v_mfma_f32_16x16x32_bf16 v[176:179], a[16:19], v[132:135], 0
    v_mfma_f32_16x16x32_bf16 v[176:179], a[20:23], v[136:139], v[176:179]
    v_mfma_f32_16x16x32_bf16 v[176:179], a[24:27], v[140:143], v[176:179]
    v_mfma_f32_16x16x32_bf16 v[176:179], a[28:31], v[144:147], v[176:179]
    v_mfma_f32_16x16x32_bf16 v[180:183], a[0:3], v[148:151], 0
    v_mfma_f32_16x16x32_bf16 v[180:183], a[4:7], v[152:155], v[180:183]
    v_mfma_f32_16x16x32_bf16 v[180:183], a[8:11], v[156:159], v[180:183]
    v_mfma_f32_16x16x32_bf16 v[180:183], a[12:15], v[160:163], v[180:183]
    v_mfma_f32_16x16x32_bf16 v[184:187], a[16:19], v[148:151], 0
    v_mfma_f32_16x16x32_bf16 v[184:187], a[20:23], v[152:155], v[184:187]
    v_mfma_f32_16x16x32_bf16 v[184:187], a[24:27], v[156:159], v[184:187]
    v_mfma_f32_16x16x32_bf16 v[184:187], a[28:31], v[160:163], v[184:187]
    v_max3_f32 v0, v0, v164, v165
    v_max3_f32 v0, v0, v166, v167
    v_max3_f32 v0, v0, v168, v169
    v_max3_f32 v0, v0, v170, v171
    v_max3_f32 v1, v1, v172, v173
    v_max3_f32 v1, v1, v174, v175
    v_max3_f32 v1, v1, v176, v177
    v_max3_f32 v1, v1, v178, v179
    v_max3_f32 v2, v2, v180, v181
    v_max3_f32 v2, v2, v182, v183
    v_max3_f32 v2, v2, v184, v185
    v_max3_f32 v2, v2, v186, v187
    s_nop 7
    s_add_u32 s82, s82, 8192
    s_cmp_lt_u32 s82, 0x20000
    s_cbranch_scc1 L_s1
    v_mov_b32 v3, v0
    s_nop 1
    v_permlane16_swap_b32 v0, v3
    v_max_f32 v0, v0, v3
    v_mov_b32 v3, v0
    s_nop 1
    v_permlane32_swap_b32 v0, v3
    v_max_f32 v0, v0, v3
    v_sub_f32 v200, 0, v0
    v_sub_f32 v201, 0, v0
    v_sub_f32 v202, 0, v0
    v_sub_f32 v203, 0, v0
    v_mov_b32 v3, v1
    s_nop 1
    v_permlane16_swap_b32 v1, v3
    v_max_f32 v1, v1, v3
    v_mov_b32 v3, v1
    s_nop 1
    v_permlane32_swap_b32 v1, v3
    v_max_f32 v1, v1, v3
    v_sub_f32 v204, 0, v1
    v_sub_f32 v205, 0, v1
    v_sub_f32 v206, 0, v1
    v_sub_f32 v207, 0, v1
    v_mov_b32 v3, v2
    s_nop 1
    v_permlane16_swap_b32 v2, v3
    v_max_f32 v2, v2, v3
    v_mov_b32 v3, v2
    s_nop 1
    v_permlane32_swap_b32 v2, v3
    v_max_f32 v2, v2, v3
    v_sub_f32 v208, 0, v2
    v_sub_f32 v209, 0, v2
    v_sub_f32 v210, 0, v2
    v_sub_f32 v211, 0, v2
    v_mov_b32 v8, 0
    v_mov_b32 v9, 0
    v_mov_b32 v10, 0
    v_mov_b32 v11, 0
    v_mov_b32 v12, 0
    v_mov_b32 v13, 0
    v_mov_b32 v14, 0
    v_mov_b32 v15, 0
    v_mov_b32 v16, 0
    v_mov_b32 v17, 0
    v_mov_b32 v18, 0
    v_mov_b32 v19, 0
    v_mov_b32 v20, 0
    v_mov_b32 v21, 0
    v_mov_b32 v22, 0
    v_mov_b32 v23, 0
    v_mov_b32 v24, 0
    v_mov_b32 v25, 0
    v_mov_b32 v26, 0
    v_mov_b32 v27, 0
    v_mov_b32 v28, 0
    v_mov_b32 v29, 0
    v_mov_b32 v30, 0
    v_mov_b32 v31, 0
    v_mov_b32 v32, 0
    v_mov_b32 v33, 0
    v_mov_b32 v34, 0
    v_mov_b32 v35, 0
    v_mov_b32 v36, 0
    v_mov_b32 v37, 0
    v_mov_b32 v38, 0
    v_mov_b32 v39, 0
    v_mov_b32 v40, 0
    v_mov_b32 v41, 0
    v_mov_b32 v42, 0
    v_mov_b32 v43, 0
    v_mov_b32 v44, 0
    v_mov_b32 v45, 0
    v_mov_b32 v46, 0
    v_mov_b32 v47, 0
    v_mov_b32 v48, 0
    v_mov_b32 v49, 0
    v_mov_b32 v50, 0
    v_mov_b32 v51, 0
    v_mov_b32 v52, 0
    v_mov_b32 v53, 0
    v_mov_b32 v54, 0
    v_mov_b32 v55, 0
    v_mov_b32 v56, 0
    v_mov_b32 v57, 0
    v_mov_b32 v58, 0
    v_mov_b32 v59, 0
    v_mov_b32 v60, 0
    v_mov_b32 v61, 0
    v_mov_b32 v62, 0
    v_mov_b32 v63, 0
    v_mov_b32 v64, 0
    v_mov_b32 v65, 0
    v_mov_b32 v66, 0
    v_mov_b32 v67, 0
    v_mov_b32 v68, 0
    v_mov_b32 v69, 0
    v_mov_b32 v70, 0
    v_mov_b32 v71, 0
    v_mov_b32 v72, 0
    v_mov_b32 v73, 0
    v_mov_b32 v74, 0
    v_mov_b32 v75, 0
    v_mov_b32 v76, 0
    v_mov_b32 v77, 0
    v_mov_b32 v78, 0
    v_mov_b32 v79, 0
    v_mov_b32 v80, 0
    v_mov_b32 v81, 0
    v_mov_b32 v82, 0
    v_mov_b32 v83, 0
    v_mov_b32 v84, 0
    v_mov_b32 v85, 0
    v_mov_b32 v86, 0
    v_mov_b32 v87, 0
    v_mov_b32 v88, 0
    v_mov_b32 v89, 0
    v_mov_b32 v90, 0
    v_mov_b32 v91, 0
    v_mov_b32 v92, 0
    v_mov_b32 v93, 0
    v_mov_b32 v94, 0
    v_mov_b32 v95, 0
    v_mov_b32 v96, 0
    v_mov_b32 v97, 0
    v_mov_b32 v98, 0
    v_mov_b32 v99, 0
    v_mov_b32 v100, 0
    v_mov_b32 v101, 0
    v_mov_b32 v102, 0
    v_mov_b32 v103, 0
    v_mov_b32 v104, 0
    v_mov_b32 v105, 0
    v_mov_b32 v106, 0
    v_mov_b32 v107, 0
    v_mov_b32 v108, 0
    v_mov_b32 v109, 0
    v_mov_b32 v110, 0
    v_mov_b32 v111, 0
    v_mov_b32 v112, 0
    v_mov_b32 v113, 0
    v_mov_b32 v114, 0
    v_mov_b32 v115, 0
    s_mov_b32 s82, 0
L_s2:
    s_add_u32 s83, s82, 4096
    buffer_load_dwordx4 a[0:3], v216, s[32:35], s82 offen offset:0
    buffer_load_dwordx4 a[4:7], v216, s[32:35], s82 offen offset:64
    buffer_load_dwordx4 a[8:11], v216, s[32:35], s82 offen offset:128
    buffer_load_dwordx4 a[12:15], v216, s[32:35], s82 offen offset:192
    buffer_load_dwordx4 a[16:19], v216, s[32:35], s83 offen offset:0
    buffer_load_dwordx4 a[20:23], v216, s[32:35], s83 offen offset:64
    buffer_load_dwordx4 a[24:27], v216, s[32:35], s83 offen offset:128
    buffer_load_dwordx4 a[28:31], v216, s[32:35], s83 offen offset:192
    s_add_u32 m0, s77, 0
    s_nop 0
    buffer_load_dwordx4 v230, s[36:39], s82 offen offset:0 lds
    buffer_load_dwordx4 v231, s[36:39], s82 offen offset:1024 lds
    buffer_load_dwordx4 v230, s[36:39], s82 offen offset:2048 lds
    buffer_load_dwordx4 v231, s[36:39], s82 offen offset:3072 lds
    s_add_u32 m0, s77, 4096
    s_nop 0
    buffer_load_dwordx4 v230, s[36:39], s83 offen offset:0 lds
    buffer_load_dwordx4 v231, s[36:39], s83 offen offset:1024 lds
    buffer_load_dwordx4 v230, s[36:39], s83 offen offset:2048 lds
    buffer_load_dwordx4 v231, s[36:39], s83 offen offset:3072 lds
    s_waitcnt vmcnt(15)
    v_mfma_f32_16x16x32_bf16 v[164:167], a[0:3], v[116:119], v[200:203]
    s_waitcnt vmcnt(14)
    v_mfma_f32_16x16x32_bf16 v[164:167], a[4:7], v[120:123], v[164:167]
    s_waitcnt vmcnt(13)
    v_mfma_f32_16x16x32_bf16 v[164:167], a[8:11], v[124:127], v[164:167]
    s_waitcnt vmcnt(12)
    v_mfma_f32_16x16x32_bf16 v[164:167], a[12:15], v[128:131], v[164:167]
    s_waitcnt vmcnt(11)
    v_mfma_f32_16x16x32_bf16 v[168:171], a[16:19], v[116:119], v[200:203]
    s_waitcnt vmcnt(10)
    v_mfma_f32_16x16x32_bf16 v[168:171], a[20:23], v[120:123], v[168:171]
    s_waitcnt vmcnt(9)
    v_mfma_f32_16x16x32_bf16 v[168:171], a[24:27], v[124:127], v[168:171]
    s_waitcnt vmcnt(8)
    v_mfma_f32_16x16x32_bf16 v[168:171], a[28:31], v[128:131], v[168:171]
    v_mfma_f32_16x16x32_bf16 v[172:175], a[0:3], v[132:135], v[204:207]
    v_mfma_f32_16x16x32_bf16 v[172:175], a[4:7], v[136:139], v[172:175]
    v_mfma_f32_16x16x32_bf16 v[172:175], a[8:11], v[140:143], v[172:175]
    v_mfma_f32_16x16x32_bf16 v[172:175], a[12:15], v[144:147], v[172:175]
    v_mfma_f32_16x16x32_bf16 v[176:179], a[16:19], v[132:135], v[204:207]
    v_mfma_f32_16x16x32_bf16 v[176:179], a[20:23], v[136:139], v[176:179]
    v_mfma_f32_16x16x32_bf16 v[176:179], a[24:27], v[140:143], v[176:179]
    v_mfma_f32_16x16x32_bf16 v[176:179], a[28:31], v[144:147], v[176:179]
    v_mfma_f32_16x16x32_bf16 v[180:183], a[0:3], v[148:151], v[208:211]
    v_mfma_f32_16x16x32_bf16 v[180:183], a[4:7], v[152:155], v[180:183]
    v_mfma_f32_16x16x32_bf16 v[180:183], a[8:11], v[156:159], v[180:183]
    v_mfma_f32_16x16x32_bf16 v[180:183], a[12:15], v[160:163], v[180:183]
    v_mfma_f32_16x16x32_bf16 v[184:187], a[16:19], v[148:151], v[208:211]
    v_mfma_f32_16x16x32_bf16 v[184:187], a[20:23], v[152:155], v[184:187]
    v_mfma_f32_16x16x32_bf16 v[184:187], a[24:27], v[156:159], v[184:187]
    v_mfma_f32_16x16x32_bf16 v[184:187], a[28:31], v[160:163], v[184:187]
    v_exp_f32 v164, v164
    v_exp_f32 v165, v165
    v_exp_f32 v166, v166
    v_exp_f32 v167, v167
    v_exp_f32 v168, v168
    v_exp_f32 v169, v169
    v_exp_f32 v170, v170
    v_exp_f32 v171, v171
    v_cvt_pk_bf16_f32 v188, v164, v165
    v_cvt_pk_bf16_f32 v189, v166, v167
    v_cvt_pk_bf16_f32 v190, v168, v169
    v_cvt_pk_bf16_f32 v191, v170, v171
    v_exp_f32 v172, v172
    v_exp_f32 v173, v173
    v_exp_f32 v174, v174
    v_exp_f32 v175, v175
    v_exp_f32 v176, v176
    v_exp_f32 v177, v177
    v_exp_f32 v178, v178
    v_exp_f32 v179, v179
    v_cvt_pk_bf16_f32 v192, v172, v173
    v_cvt_pk_bf16_f32 v193, v174, v175
    v_cvt_pk_bf16_f32 v194, v176, v177
    v_cvt_pk_bf16_f32 v195, v178, v179
    v_exp_f32 v180, v180
    v_exp_f32 v181, v181
    v_exp_f32 v182, v182
    v_exp_f32 v183, v183
    v_exp_f32 v184, v184
    v_exp_f32 v185, v185
    v_exp_f32 v186, v186
    v_exp_f32 v187, v187
    v_cvt_pk_bf16_f32 v196, v180, v181
    v_cvt_pk_bf16_f32 v197, v182, v183
    v_cvt_pk_bf16_f32 v198, v184, v185
    v_cvt_pk_bf16_f32 v199, v186, v187
    s_waitcnt vmcnt(0)
    ds_read_b64_tr_b16 a[32:33], v232 offset:0
    ds_read_b64_tr_b16 a[34:35], v232 offset:4096
    ds_read_b64_tr_b16 a[36:37], v233 offset:0
    ds_read_b64_tr_b16 a[38:39], v233 offset:4096
    ds_read_b64_tr_b16 a[40:41], v234 offset:0
    ds_read_b64_tr_b16 a[42:43], v234 offset:4096
    ds_read_b64_tr_b16 a[44:45], v235 offset:0
    ds_read_b64_tr_b16 a[46:47], v235 offset:4096
    ds_read_b64_tr_b16 a[48:49], v236 offset:0
    ds_read_b64_tr_b16 a[50:51], v236 offset:4096
    ds_read_b64_tr_b16 a[52:53], v237 offset:0
    ds_read_b64_tr_b16 a[54:55], v237 offset:4096
    ds_read_b64_tr_b16 a[56:57], v238 offset:0
    ds_read_b64_tr_b16 a[58:59], v238 offset:4096
    ds_read_b64_tr_b16 a[60:61], v239 offset:0
    ds_read_b64_tr_b16 a[62:63], v239 offset:4096
    v_mfma_f32_16x16x32_bf16 v[104:107], v[212:215], v[188:191], v[104:107]
    s_waitcnt lgkmcnt(14)
    v_mfma_f32_16x16x32_bf16 v[8:11], a[32:35], v[188:191], v[8:11]
    s_waitcnt lgkmcnt(12)
    v_mfma_f32_16x16x32_bf16 v[12:15], a[36:39], v[188:191], v[12:15]
    s_waitcnt lgkmcnt(10)
    v_mfma_f32_16x16x32_bf16 v[16:19], a[40:43], v[188:191], v[16:19]
    s_waitcnt lgkmcnt(8)
    v_mfma_f32_16x16x32_bf16 v[20:23], a[44:47], v[188:191], v[20:23]
    s_waitcnt lgkmcnt(6)
    v_mfma_f32_16x16x32_bf16 v[24:27], a[48:51], v[188:191], v[24:27]
    s_waitcnt lgkmcnt(4)
    v_mfma_f32_16x16x32_bf16 v[28:31], a[52:55], v[188:191], v[28:31]
    s_waitcnt lgkmcnt(2)
    v_mfma_f32_16x16x32_bf16 v[32:35], a[56:59], v[188:191], v[32:35]
    s_waitcnt lgkmcnt(0)
    v_mfma_f32_16x16x32_bf16 v[36:39], a[60:63], v[188:191], v[36:39]
    v_mfma_f32_16x16x32_bf16 v[108:111], v[212:215], v[192:195], v[108:111]
    v_mfma_f32_16x16x32_bf16 v[40:43], a[32:35], v[192:195], v[40:43]
    v_mfma_f32_16x16x32_bf16 v[44:47], a[36:39], v[192:195], v[44:47]
    v_mfma_f32_16x16x32_bf16 v[48:51], a[40:43], v[192:195], v[48:51]
    v_mfma_f32_16x16x32_bf16 v[52:55], a[44:47], v[192:195], v[52:55]
    v_mfma_f32_16x16x32_bf16 v[56:59], a[48:51], v[192:195], v[56:59]
    v_mfma_f32_16x16x32_bf16 v[60:63], a[52:55], v[192:195], v[60:63]
    v_mfma_f32_16x16x32_bf16 v[64:67], a[56:59], v[192:195], v[64:67]
    v_mfma_f32_16x16x32_bf16 v[68:71], a[60:63], v[192:195], v[68:71]
    v_mfma_f32_16x16x32_bf16 v[112:115], v[212:215], v[196:199], v[112:115]
    v_mfma_f32_16x16x32_bf16 v[72:75], a[32:35], v[196:199], v[72:75]
    v_mfma_f32_16x16x32_bf16 v[76:79], a[36:39], v[196:199], v[76:79]
    v_mfma_f32_16x16x32_bf16 v[80:83], a[40:43], v[196:199], v[80:83]
    v_mfma_f32_16x16x32_bf16 v[84:87], a[44:47], v[196:199], v[84:87]
    v_mfma_f32_16x16x32_bf16 v[88:91], a[48:51], v[196:199], v[88:91]
    v_mfma_f32_16x16x32_bf16 v[92:95], a[52:55], v[196:199], v[92:95]
    v_mfma_f32_16x16x32_bf16 v[96:99], a[56:59], v[196:199], v[96:99]
    v_mfma_f32_16x16x32_bf16 v[100:103], a[60:63], v[196:199], v[100:103]
    s_nop 7
    s_add_u32 s82, s82, 8192
    s_cmp_lt_u32 s82, 0x20000
    s_cbranch_scc1 L_s2
    v_rcp_f32 v105, v104
    s_nop 0
    v_mul_f32 v8, v105, v8
    v_mul_f32 v9, v105, v9
    v_mul_f32 v10, v105, v10
    v_mul_f32 v11, v105, v11
    v_cvt_pk_bf16_f32 v164, v8, v9
    v_cvt_pk_bf16_f32 v165, v10, v11
    v_mul_f32 v12, v105, v12
    v_mul_f32 v13, v105, v13
    v_mul_f32 v14, v105, v14
    v_mul_f32 v15, v105, v15
    v_cvt_pk_bf16_f32 v166, v12, v13
    v_cvt_pk_bf16_f32 v167, v14, v15
    s_add_u32 s79, s86, 0
    buffer_store_dwordx4 v[164:167], v248, s[44:47], s79 offen sc1
    v_mul_f32 v16, v105, v16
    v_mul_f32 v17, v105, v17
    v_mul_f32 v18, v105, v18
    v_mul_f32 v19, v105, v19
    v_cvt_pk_bf16_f32 v168, v16, v17
    v_cvt_pk_bf16_f32 v169, v18, v19
    v_mul_f32 v20, v105, v20
    v_mul_f32 v21, v105, v21
    v_mul_f32 v22, v105, v22
    v_mul_f32 v23, v105, v23
    v_cvt_pk_bf16_f32 v170, v20, v21
    v_cvt_pk_bf16_f32 v171, v22, v23
    buffer_store_dwordx4 v[168:171], v248, s[44:47], s79 offen offset:1024 sc1
    v_mul_f32 v24, v105, v24
    v_mul_f32 v25, v105, v25
    v_mul_f32 v26, v105, v26
    v_mul_f32 v27, v105, v27
    v_cvt_pk_bf16_f32 v188, v24, v25
    v_cvt_pk_bf16_f32 v189, v26, v27
    v_mul_f32 v28, v105, v28
    v_mul_f32 v29, v105, v29
    v_mul_f32 v30, v105, v30
    v_mul_f32 v31, v105, v31
    v_cvt_pk_bf16_f32 v190, v28, v29
    v_cvt_pk_bf16_f32 v191, v30, v31
    buffer_store_dwordx4 v[188:191], v248, s[44:47], s79 offen offset:2048 sc1
    v_mul_f32 v32, v105, v32
    v_mul_f32 v33, v105, v33
    v_mul_f32 v34, v105, v34
    v_mul_f32 v35, v105, v35
    v_cvt_pk_bf16_f32 v204, v32, v33
    v_cvt_pk_bf16_f32 v205, v34, v35
    v_mul_f32 v36, v105, v36
    v_mul_f32 v37, v105, v37
    v_mul_f32 v38, v105, v38
    v_mul_f32 v39, v105, v39
    v_cvt_pk_bf16_f32 v206, v36, v37
    v_cvt_pk_bf16_f32 v207, v38, v39
    buffer_store_dwordx4 v[204:207], v248, s[44:47], s79 offen offset:3072 sc1
    v_rcp_f32 v109, v108
    s_nop 0
    v_mul_f32 v40, v109, v40
    v_mul_f32 v41, v109, v41
    v_mul_f32 v42, v109, v42
    v_mul_f32 v43, v109, v43
    v_cvt_pk_bf16_f32 v172, v40, v41
    v_cvt_pk_bf16_f32 v173, v42, v43
    v_mul_f32 v44, v109, v44
    v_mul_f32 v45, v109, v45
    v_mul_f32 v46, v109, v46
    v_mul_f32 v47, v109, v47
    v_cvt_pk_bf16_f32 v174, v44, v45
    v_cvt_pk_bf16_f32 v175, v46, v47
    s_add_u32 s79, s86, 4096
    buffer_store_dwordx4 v[172:175], v248, s[44:47], s79 offen sc1
    v_mul_f32 v48, v109, v48
    v_mul_f32 v49, v109, v49
    v_mul_f32 v50, v109, v50
    v_mul_f32 v51, v109, v51
    v_cvt_pk_bf16_f32 v176, v48, v49
    v_cvt_pk_bf16_f32 v177, v50, v51
    v_mul_f32 v52, v109, v52
    v_mul_f32 v53, v109, v53
    v_mul_f32 v54, v109, v54
    v_mul_f32 v55, v109, v55
    v_cvt_pk_bf16_f32 v178, v52, v53
    v_cvt_pk_bf16_f32 v179, v54, v55
    buffer_store_dwordx4 v[176:179], v248, s[44:47], s79 offen offset:1024 sc1
    v_mul_f32 v56, v109, v56
    v_mul_f32 v57, v109, v57
    v_mul_f32 v58, v109, v58
    v_mul_f32 v59, v109, v59
    v_cvt_pk_bf16_f32 v192, v56, v57
    v_cvt_pk_bf16_f32 v193, v58, v59
    v_mul_f32 v60, v109, v60
    v_mul_f32 v61, v109, v61
    v_mul_f32 v62, v109, v62
    v_mul_f32 v63, v109, v63
    v_cvt_pk_bf16_f32 v194, v60, v61
    v_cvt_pk_bf16_f32 v195, v62, v63
    buffer_store_dwordx4 v[192:195], v248, s[44:47], s79 offen offset:2048 sc1
    v_mul_f32 v64, v109, v64
    v_mul_f32 v65, v109, v65
    v_mul_f32 v66, v109, v66
    v_mul_f32 v67, v109, v67
    v_cvt_pk_bf16_f32 v208, v64, v65
    v_cvt_pk_bf16_f32 v209, v66, v67
    v_mul_f32 v68, v109, v68
    v_mul_f32 v69, v109, v69
    v_mul_f32 v70, v109, v70
    v_mul_f32 v71, v109, v71
    v_cvt_pk_bf16_f32 v210, v68, v69
    v_cvt_pk_bf16_f32 v211, v70, v71
    buffer_store_dwordx4 v[208:211], v248, s[44:47], s79 offen offset:3072 sc1
    v_rcp_f32 v113, v112
    s_nop 0
    v_pk_mul_f32 v[72:73], v[72:73], v[112:113] op_sel:[0,1] op_sel_hi:[1,1]
    v_pk_mul_f32 v[74:75], v[74:75], v[112:113] op_sel:[0,1] op_sel_hi:[1,1]
    v_cvt_pk_bf16_f32 v180, v72, v73
    v_cvt_pk_bf16_f32 v181, v74, v75
    v_pk_mul_f32 v[76:77], v[76:77], v[112:113] op_sel:[0,1] op_sel_hi:[1,1]
    v_pk_mul_f32 v[78:79], v[78:79], v[112:113] op_sel:[0,1] op_sel_hi:[1,1]
    v_cvt_pk_bf16_f32 v182, v76, v77
    v_cvt_pk_bf16_f32 v183, v78, v79
    s_add_u32 s79, s86, 8192
    buffer_store_dwordx4 v[180:183], v248, s[44:47], s79 offen sc1
    v_pk_mul_f32 v[80:81], v[80:81], v[112:113] op_sel:[0,1] op_sel_hi:[1,1]
    v_pk_mul_f32 v[82:83], v[82:83], v[112:113] op_sel:[0,1] op_sel_hi:[1,1]
    v_cvt_pk_bf16_f32 v184, v80, v81
    v_cvt_pk_bf16_f32 v185, v82, v83
    v_pk_mul_f32 v[84:85], v[84:85], v[112:113] op_sel:[0,1] op_sel_hi:[1,1]
    v_pk_mul_f32 v[86:87], v[86:87], v[112:113] op_sel:[0,1] op_sel_hi:[1,1]
    v_cvt_pk_bf16_f32 v186, v84, v85
    v_cvt_pk_bf16_f32 v187, v86, v87
    buffer_store_dwordx4 v[184:187], v248, s[44:47], s79 offen offset:1024 sc1
    v_pk_mul_f32 v[88:89], v[88:89], v[112:113] op_sel:[0,1] op_sel_hi:[1,1]
    v_pk_mul_f32 v[90:91], v[90:91], v[112:113] op_sel:[0,1] op_sel_hi:[1,1]
    v_cvt_pk_bf16_f32 v196, v88, v89
    v_cvt_pk_bf16_f32 v197, v90, v91
    v_pk_mul_f32 v[92:93], v[92:93], v[112:113] op_sel:[0,1] op_sel_hi:[1,1]
    v_pk_mul_f32 v[94:95], v[94:95], v[112:113] op_sel:[0,1] op_sel_hi:[1,1]
    v_cvt_pk_bf16_f32 v198, v92, v93
    v_cvt_pk_bf16_f32 v199, v94, v95
    buffer_store_dwordx4 v[196:199], v248, s[44:47], s79 offen offset:2048 sc1
    v_pk_mul_f32 v[96:97], v[96:97], v[112:113] op_sel:[0,1] op_sel_hi:[1,1]
    v_pk_mul_f32 v[98:99], v[98:99], v[112:113] op_sel:[0,1] op_sel_hi:[1,1]
    v_cvt_pk_bf16_f32 v200, v96, v97
    v_cvt_pk_bf16_f32 v201, v98, v99
    v_pk_mul_f32 v[100:101], v[100:101], v[112:113] op_sel:[0,1] op_sel_hi:[1,1]
    v_pk_mul_f32 v[102:103], v[102:103], v[112:113] op_sel:[0,1] op_sel_hi:[1,1]
    v_cvt_pk_bf16_f32 v202, v100, v101
    v_cvt_pk_bf16_f32 v203, v102, v103
    buffer_store_dwordx4 v[200:203], v248, s[44:47], s79 offen offset:3072 sc1
    s_waitcnt vmcnt(0) lgkmcnt(0)
    s_branch L_back
.section .rodata,"a"
.p2align 6
.amdhsa_kernel standalone__mha_block_cached__near_ridge_kernel
  .amdhsa_next_free_vgpr 512
  .amdhsa_next_free_sgpr 102
  .amdhsa_accum_offset 256
  .amdhsa_group_segment_fixed_size 0
  .amdhsa_kernarg_size 64
  .amdhsa_user_sgpr_count 2
  .amdhsa_user_sgpr_kernarg_segment_ptr 1
  .amdhsa_system_sgpr_workgroup_id_x 1
.end_amdhsa_kernel
```
